```python
import torch

def _softmax(x, axis=-1):
    return torch.softmax(x, dim=axis)
def _gelu(x):
    return torch.nn.functional.gelu(x, approximate="tanh")
def _silu(x):
    return torch.nn.functional.silu(x)
def _sigmoid(x):
    return torch.sigmoid(x)
def _layernorm(x, axis=-1, eps=1e-5):
    m = x.mean(dim=axis, keepdim=True)
    v = x.var(dim=axis, keepdim=True, unbiased=False)
    return (x - m) / torch.sqrt(v + eps)
def _scatter_add(tgt, idx, src, axis=0):
    return tgt.clone().index_add_(axis, idx, src)
def _segment_sum(src, seg, n):
    out = torch.zeros((n,) + src.shape[1:], dtype=src.dtype)
    return out.index_add_(0, seg, src)
def _pad(x, pw):
    flat = tuple(v for pair in reversed(pw) for v in pair)
    return torch.nn.functional.pad(x, flat)

kernel_name = 'standalone__molecular_angular_gemnet__graph'

def setup_inputs():

    _w = (lambda a: (lambda t: t.to(torch.bfloat16) if t.is_floating_point() else t)(torch.as_tensor(a)))
    N, deg, De, L = 10000, 16, 16, 1
    E = N * deg
    T = E * deg
    NR = 8
    dist = torch.rand(E).to(float)
    angle = (torch.rand(T) * torch.pi).to(float)
    centers = torch.linspace(0.0, 1.0, NR).to(float)
    ang_freq = torch.arange(1, L + 1).to(float)
    return {
        "m": _w((lambda *s: torch.randn(*s, dtype=torch.bfloat16) * 0.05)(E, De)),
        "idx_in": _w((lambda lo, hi, *s: torch.randint(lo, hi, s))(0, E, T).to(torch.int64)),
        "idx_out": _w((lambda lo, hi, *s: torch.randint(lo, hi, s))(0, E, T).to(torch.int64)),
        "dist": _w(dist),
        "angle": _w(angle),
        "centers": _w(centers),
        "ang_freq": _w(ang_freq),
        "w_rbf": _w((lambda *s: torch.randn(*s, dtype=torch.bfloat16) * 0.2)(NR, De)),
        "w_sbf": _w((lambda *s: torch.randn(*s, dtype=torch.bfloat16) * 0.2)(NR * L, De)),
        "w_down": _w((lambda *s: torch.randn(*s, dtype=torch.bfloat16) * 0.2)(De, De)),
        "w_up": _w((lambda *s: torch.randn(*s, dtype=torch.bfloat16) * 0.2)(De, De)),
    }

def reference(m, idx_in, idx_out, dist, angle, centers, ang_freq, w_rbf, w_sbf, w_down, w_up):
    E, De = m.shape[0], m.shape[1]
    NR = centers.shape[0]
    L = ang_freq.shape[0]
    rbf = torch.exp(-10.0 * (dist[:, None] - centers[None, :]) ** 2)
    cbf = torch.cos(ang_freq[None, :] * angle[:, None])
    rbf_t = rbf[idx_out]
    sbf = torch.reshape(rbf_t[:, :, None] * cbf[:, None, :], (-1, NR * L))
    x = (m[idx_in] @ w_down) * (sbf @ w_sbf)
    agg = _segment_sum(x, idx_out, E)
    return m + (agg @ w_up) * (rbf @ w_rbf)
```

```asm
; @launch grid=(256,1,1) block=(512,1,1) lds=147200
.amdgcn_target "amdgcn-amd-amdhsa--gfx950"
.text
.globl standalone__molecular_angular_gemnet__graph_kernel
.p2align 8
.type standalone__molecular_angular_gemnet__graph_kernel,@function
standalone__molecular_angular_gemnet__graph_kernel:
    s_cmp_ge_u32 s2, 256
    s_cbranch_scc1 L_end
    s_load_dwordx16 s[44:59], s[0:1], 0
    s_load_dwordx8 s[60:67], s[0:1], 64
    s_load_dwordx4 s[68:71], s[0:1], 96
    s_getpc_b64 s[96:97]
    s_lshr_b32 s90, s2, 3
    s_mul_i32 s90, s90, 6
    v_add_u32 v1, s90, v0
    v_min_u32 v1, (L_code_end - standalone__molecular_angular_gemnet__graph_kernel - 256) / 128, v1
    v_lshlrev_b32 v1, 7, v1
    v_mov_b32 v3, s97
    v_add_co_u32 v2, vcc, s96, v1
    s_nop 1
    v_addc_co_u32 v3, vcc, 0, v3, vcc
    v_cmp_gt_u32 vcc, 6, v0
    s_and_saveexec_b64 s[90:91], vcc
    s_cbranch_execz L_noipf
    global_load_dword v130, v[2:3], off
L_noipf:
    s_mov_b64 exec, s[90:91]
    v_lshlrev_b32 v1, 4, v0
    v_lshlrev_b32 v2, 3, v0
    v_lshlrev_b32 v5, 2, v0
    v_mov_b32 v6, 0
    v_mov_b32 v3, 1
    v_lshrrev_b32 v7, 6, v0
    s_mul_i32 s72, s2, 40000
    s_mul_i32 s77, s2, 20000
    v_readfirstlane_b32 s88, v7
    ds_write_b32 v5, v6 offset:1024
    s_add_u32 s73, s72, 8000
    s_add_u32 s78, s77, 4000
    s_add_u32 s74, s72, 16000
    s_add_u32 s79, s77, 8000
    s_add_u32 s75, s72, 24000
    s_add_u32 s80, s77, 12000
    s_add_u32 s76, s72, 32000
    s_add_u32 s81, s77, 16000
    s_and_b32 s3, s2, 7
    s_lshl_b32 s3, s3, 5
    s_lshr_b32 s90, s2, 3
    s_add_u32 s3, s3, s90
    s_mov_b32 s82, 6871948
    s_mov_b32 s83, -625
    s_mov_b32 s85, 0x4007
    s_mov_b32 s89, 0
    v_cmp_gt_u32 vcc, 500, v0
    s_lshl_b32 s92, s2, 10
    s_cmp_eq_u32 s88, 0
    s_cselect_b64 s[90:91], -1, 0
    s_waitcnt lgkmcnt(0)
    s_mov_b32 s4, s48
    s_and_b32 s5, s49, 0xffff
    s_mov_b32 s6, 10240000
    s_mov_b32 s7, 0x20000
    s_barrier
    s_mov_b64 s[86:87], vcc
    s_mov_b64 exec, vcc
    buffer_load_dwordx4 v[8:11], v1, s[4:7], s72 offen nt
    buffer_load_dwordx4 v[12:15], v1, s[4:7], s73 offen nt
    buffer_load_dwordx4 v[16:19], v1, s[4:7], s74 offen nt
    buffer_load_dwordx4 v[20:23], v1, s[4:7], s75 offen nt
    buffer_load_dwordx4 v[24:27], v1, s[4:7], s76 offen nt
    global_load_ushort v4, v6, s[56:57]
    s_mov_b32 s8, s46
    s_and_b32 s9, s47, 0xffff
    s_mov_b32 s10, 10240000
    s_mov_b32 s11, 0x20000
    s_mov_b32 s12, s52
    s_and_b32 s13, s53, 0xffff
    s_mov_b32 s14, 5120000
    s_mov_b32 s15, 0x20000
    s_mov_b32 s40, s68
    s_and_b32 s41, s69, 0xffff
    s_mov_b32 s42, 256
    s_mov_b32 s43, 0x20000
    s_mov_b32 s24, s70
    s_and_b32 s25, s71, 0xffff
    s_mov_b32 s26, 13795328
    s_mov_b32 s27, 0x20000
    s_mov_b32 s32, s66
    s_and_b32 s33, s67, 0xffff
    s_mov_b32 s34, 5120000
    s_mov_b32 s35, 0x20000
    s_mov_b32 s28, s44
    s_and_b32 s29, s45, 0xffff
    s_mov_b32 s30, 5120000
    s_mov_b32 s31, 0x20000
    s_mov_b32 s36, s50
    s_and_b32 s37, s51, 0xffff
    s_mov_b32 s38, 320000
    s_mov_b32 s39, 0x20000
    s_add_u32 s20, s70, 16777216
    s_addc_u32 s21, s71, 0
    s_and_b32 s21, s21, 0xffff
    s_mov_b32 s22, 262144
    s_mov_b32 s23, 0x20000
    s_mul_i32 s93, s2, 53888
    s_add_u32 s16, s70, s93
    s_addc_u32 s17, s71, 0
    s_and_b32 s17, s17, 0xffff
    s_mov_b32 s18, 0
    s_mov_b32 s19, 0x20000
    s_mov_b64 exec, -1
    v_and_b32 v125, 3, v0
    v_lshlrev_b32 v125, 6, v125
    v_lshlrev_b32 v102, 4, v0
    v_mov_b32 v248, 0
    v_mov_b32 v249, 0
    v_mov_b32 v250, 0
    v_mov_b32 v251, 0
    v_add_u32 v102, 92288, v102
    v_add_u32 v103, 65536, v102
    ds_write_b128 v102, v[248:251] offset:0
    ds_write_b128 v102, v[248:251] offset:8192
    ds_write_b128 v102, v[248:251] offset:16384
    ds_write_b128 v102, v[248:251] offset:24576
    ds_write_b128 v102, v[248:251] offset:32768
    ds_write_b128 v102, v[248:251] offset:40960
    ds_write_b128 v102, v[248:251] offset:49152
    s_mov_b64 exec, s[86:87]
    s_waitcnt vmcnt(5)
    s_cmp_lg_u32 s88, 0
    s_cbranch_scc1 L_w0z
    buffer_store_dwordx4 v[248:251], v1, s[20:23], s92 offen sc1
    s_mov_b64 exec, s[86:87]
L_w0z:
    v_mul_hi_u32_u24 v98, s82, v8
    v_add_u32 v8, 16, v8
    v_mul_hi_u32_u24 v99, s82, v9
    v_add_u32 v9, 16, v9
    v_mul_hi_u32_u24 v100, s82, v10
    v_add_u32 v10, 16, v10
    v_mul_hi_u32_u24 v101, s82, v11
    v_add_u32 v11, 16, v11
    v_lshlrev_b32 v58, 2, v98
    v_mad_i32_i24 v8, v98, s83, v8
    ds_add_rtn_u32 v78, v58, v3 offset:1024
    v_lshlrev_b32 v59, 2, v99
    v_mad_i32_i24 v9, v99, s83, v9
    ds_add_rtn_u32 v79, v59, v3 offset:1024
    v_lshlrev_b32 v60, 2, v100
    v_mad_i32_i24 v10, v100, s83, v10
    ds_add_rtn_u32 v80, v60, v3 offset:1024
    v_lshlrev_b32 v61, 2, v101
    v_mad_i32_i24 v11, v101, s83, v11
    ds_add_rtn_u32 v81, v61, v3 offset:1024
    v_lshl_or_b32 v8, v8, 11, v8
    v_lshl_or_b32 v9, v9, 11, v9
    v_lshl_or_b32 v10, v10, 11, v10
    v_lshl_or_b32 v11, v11, 11, v11
    s_waitcnt vmcnt(4)
    v_mul_hi_u32_u24 v98, s82, v12
    v_add_u32 v12, 16, v12
    v_mul_hi_u32_u24 v99, s82, v13
    v_add_u32 v13, 16, v13
    v_mul_hi_u32_u24 v100, s82, v14
    v_add_u32 v14, 16, v14
    v_mul_hi_u32_u24 v101, s82, v15
    v_add_u32 v15, 16, v15
    v_lshlrev_b32 v62, 2, v98
    v_mad_i32_i24 v12, v98, s83, v12
    ds_add_rtn_u32 v82, v62, v3 offset:1024
    v_lshlrev_b32 v63, 2, v99
    v_mad_i32_i24 v13, v99, s83, v13
    ds_add_rtn_u32 v83, v63, v3 offset:1024
    v_lshlrev_b32 v64, 2, v100
    v_mad_i32_i24 v14, v100, s83, v14
    ds_add_rtn_u32 v84, v64, v3 offset:1024
    v_lshlrev_b32 v65, 2, v101
    v_mad_i32_i24 v15, v101, s83, v15
    ds_add_rtn_u32 v85, v65, v3 offset:1024
    v_lshl_or_b32 v12, v12, 11, v12
    v_lshl_or_b32 v13, v13, 11, v13
    v_lshl_or_b32 v14, v14, 11, v14
    v_lshl_or_b32 v15, v15, 11, v15
    s_waitcnt vmcnt(3)
    v_mul_hi_u32_u24 v98, s82, v16
    v_add_u32 v16, 16, v16
    v_mul_hi_u32_u24 v99, s82, v17
    v_add_u32 v17, 16, v17
    v_mul_hi_u32_u24 v100, s82, v18
    v_add_u32 v18, 16, v18
    v_mul_hi_u32_u24 v101, s82, v19
    v_add_u32 v19, 16, v19
    v_lshlrev_b32 v66, 2, v98
    v_mad_i32_i24 v16, v98, s83, v16
    ds_add_rtn_u32 v86, v66, v3 offset:1024
    v_lshlrev_b32 v67, 2, v99
    v_mad_i32_i24 v17, v99, s83, v17
    ds_add_rtn_u32 v87, v67, v3 offset:1024
    v_lshlrev_b32 v68, 2, v100
    v_mad_i32_i24 v18, v100, s83, v18
    ds_add_rtn_u32 v88, v68, v3 offset:1024
    v_lshlrev_b32 v69, 2, v101
    v_mad_i32_i24 v19, v101, s83, v19
    ds_add_rtn_u32 v89, v69, v3 offset:1024
    v_lshl_or_b32 v16, v16, 11, v16
    v_lshl_or_b32 v17, v17, 11, v17
    v_lshl_or_b32 v18, v18, 11, v18
    v_lshl_or_b32 v19, v19, 11, v19
    s_waitcnt vmcnt(2)
    v_mul_hi_u32_u24 v98, s82, v20
    v_add_u32 v20, 16, v20
    v_mul_hi_u32_u24 v99, s82, v21
    v_add_u32 v21, 16, v21
    v_mul_hi_u32_u24 v100, s82, v22
    v_add_u32 v22, 16, v22
    v_mul_hi_u32_u24 v101, s82, v23
    v_add_u32 v23, 16, v23
    v_lshlrev_b32 v70, 2, v98
    v_mad_i32_i24 v20, v98, s83, v20
    ds_add_rtn_u32 v90, v70, v3 offset:1024
    v_lshlrev_b32 v71, 2, v99
    v_mad_i32_i24 v21, v99, s83, v21
    ds_add_rtn_u32 v91, v71, v3 offset:1024
    v_lshlrev_b32 v72, 2, v100
    v_mad_i32_i24 v22, v100, s83, v22
    ds_add_rtn_u32 v92, v72, v3 offset:1024
    v_lshlrev_b32 v73, 2, v101
    v_mad_i32_i24 v23, v101, s83, v23
    ds_add_rtn_u32 v93, v73, v3 offset:1024
    v_lshl_or_b32 v20, v20, 11, v20
    v_lshl_or_b32 v21, v21, 11, v21
    v_lshl_or_b32 v22, v22, 11, v22
    v_lshl_or_b32 v23, v23, 11, v23
    s_waitcnt vmcnt(1)
    v_mul_hi_u32_u24 v98, s82, v24
    v_add_u32 v24, 16, v24
    v_mul_hi_u32_u24 v99, s82, v25
    v_add_u32 v25, 16, v25
    v_mul_hi_u32_u24 v100, s82, v26
    v_add_u32 v26, 16, v26
    v_mul_hi_u32_u24 v101, s82, v27
    v_add_u32 v27, 16, v27
    v_lshlrev_b32 v74, 2, v98
    v_mad_i32_i24 v24, v98, s83, v24
    ds_add_rtn_u32 v94, v74, v3 offset:1024
    v_lshlrev_b32 v75, 2, v99
    v_mad_i32_i24 v25, v99, s83, v25
    ds_add_rtn_u32 v95, v75, v3 offset:1024
    v_lshlrev_b32 v76, 2, v100
    v_mad_i32_i24 v26, v100, s83, v26
    ds_add_rtn_u32 v96, v76, v3 offset:1024
    v_lshlrev_b32 v77, 2, v101
    v_mad_i32_i24 v27, v101, s83, v27
    ds_add_rtn_u32 v97, v77, v3 offset:1024
    v_lshl_or_b32 v24, v24, 11, v24
    v_lshl_or_b32 v25, v25, 11, v25
    v_lshl_or_b32 v26, v26, 11, v26
    v_lshl_or_b32 v27, v27, 11, v27
    s_cmp_lt_u32 s88, 4
    s_cbranch_scc0 L_resta
    buffer_load_dwordx2 v[48:49], v2, s[12:15], s77 offen nt
    buffer_load_dwordx2 v[50:51], v2, s[12:15], s78 offen nt
    buffer_load_dwordx2 v[52:53], v2, s[12:15], s79 offen nt
    buffer_load_dwordx2 v[54:55], v2, s[12:15], s80 offen nt
    buffer_load_dwordx2 v[56:57], v2, s[12:15], s81 offen nt
    buffer_load_dwordx4 v[28:31], v1, s[8:11], s72 offen nt
    buffer_load_dwordx4 v[32:35], v1, s[8:11], s73 offen nt
    buffer_load_dwordx4 v[36:39], v1, s[8:11], s74 offen nt
    buffer_load_dwordx4 v[40:43], v1, s[8:11], s75 offen nt
    buffer_load_dwordx4 v[44:47], v1, s[8:11], s76 offen nt
L_resta:
    s_cmp_lg_u32 s88, 0
    s_cbranch_scc1 L_w0w
    s_mov_b32 exec_lo, -1
    s_mov_b32 exec_hi, 0
    global_load_dwordx4 v[116:119], v1, s[62:63] offset:0
    s_mov_b32 exec_lo, 0
    s_mov_b32 exec_hi, -1
    global_load_dwordx4 v[116:119], v1, s[64:65] offset:-512
    s_mov_b32 exec_lo, 65535
    s_mov_b32 exec_hi, 0
    global_load_dwordx4 v[120:123], v1, s[60:61] offset:0
    s_mov_b32 exec_lo, 4294901760
    s_mov_b32 exec_hi, 0
    global_load_dwordx4 v[120:123], v1, s[58:59] offset:-256
    s_mov_b32 exec_lo, 0
    s_mov_b32 exec_hi, 1
    global_load_dwordx4 v[120:123], v1, s[54:55] offset:-512
    s_mov_b64 exec, s[86:87]
L_w0w:
    s_waitcnt lgkmcnt(0)
    s_barrier
    s_cmp_lt_u32 s88, 4
    s_cbranch_scc1 L_restb
    buffer_load_dwordx2 v[48:49], v2, s[12:15], s77 offen nt
    buffer_load_dwordx2 v[50:51], v2, s[12:15], s78 offen nt
    buffer_load_dwordx2 v[52:53], v2, s[12:15], s79 offen nt
    buffer_load_dwordx2 v[54:55], v2, s[12:15], s80 offen nt
    buffer_load_dwordx2 v[56:57], v2, s[12:15], s81 offen nt
    buffer_load_dwordx4 v[28:31], v1, s[8:11], s72 offen nt
    buffer_load_dwordx4 v[32:35], v1, s[8:11], s73 offen nt
    buffer_load_dwordx4 v[36:39], v1, s[8:11], s74 offen nt
    buffer_load_dwordx4 v[40:43], v1, s[8:11], s75 offen nt
    buffer_load_dwordx4 v[44:47], v1, s[8:11], s76 offen nt
L_restb:
    s_mov_b64 exec, -1
    v_and_b32 v107, 63, v0
    v_lshlrev_b32 v107, 4, v107
    ds_read_b128 v[98:101], v107 offset:1024
    s_mov_b32 s94, 92288
    s_waitcnt lgkmcnt(0)
    v_add_u32 v98, 3, v98
    v_lshrrev_b32 v98, 2, v98
    v_add_u32 v99, 3, v99
    v_lshrrev_b32 v99, 2, v99
    v_add_u32 v100, 3, v100
    v_lshrrev_b32 v100, 2, v100
    v_add_u32 v101, 3, v101
    v_lshrrev_b32 v101, 2, v101
    v_add_u32 v104, v98, v99
    v_add_u32 v105, v104, v100
    v_add_u32 v102, v105, v101
    v_mov_b32 v106, v102
    s_nop 1
    v_add_u32_dpp v106, v106, v106 row_shr:1 row_mask:0xf bank_mask:0xf
    s_nop 1
    v_add_u32_dpp v106, v106, v106 row_shr:2 row_mask:0xf bank_mask:0xf
    s_nop 1
    v_add_u32_dpp v106, v106, v106 row_shr:4 row_mask:0xf bank_mask:0xf
    s_nop 1
    v_add_u32_dpp v106, v106, v106 row_shr:8 row_mask:0xf bank_mask:0xf
    s_nop 1
    v_add_u32_dpp v106, v106, v106 row_bcast:15 row_mask:0xa bank_mask:0xf
    s_nop 1
    v_add_u32_dpp v106, v106, v106 row_bcast:31 row_mask:0xc bank_mask:0xf
    v_sub_u32 v102, v106, v102
    v_add_u32 v103, v102, v98
    v_add_u32 v104, v102, v104
    v_add_u32 v105, v102, v105
    v_readlane_b32 s95, v106, 63
    v_lshl_or_b32 v112, v98, 12, v102
    v_mad_u32_u24 v102, v102, 20, s94
    v_lshl_or_b32 v113, v99, 12, v103
    v_mad_u32_u24 v103, v103, 20, s94
    v_lshl_or_b32 v114, v100, 12, v104
    v_mad_u32_u24 v104, v104, 20, s94
    v_lshl_or_b32 v115, v101, 12, v105
    v_mad_u32_u24 v105, v105, 20, s94
    ds_write_b128 v107, v[102:105] offset:2048
    v_or_b32 v112, 0x80000000, v112
    v_or_b32 v113, 0x80000000, v113
    v_or_b32 v114, 0x80000000, v114
    v_or_b32 v115, 0x80000000, v115
    s_mul_i32 s18, s95, 20
    s_mov_b64 exec, s[86:87]
    ds_read_b32 v58, v58 offset:2048
    ds_read_b32 v59, v59 offset:2048
    ds_read_b32 v60, v60 offset:2048
    ds_read_b32 v61, v61 offset:2048
    ds_read_b32 v62, v62 offset:2048
    ds_read_b32 v63, v63 offset:2048
    ds_read_b32 v64, v64 offset:2048
    ds_read_b32 v65, v65 offset:2048
    ds_read_b32 v66, v66 offset:2048
    ds_read_b32 v67, v67 offset:2048
    ds_read_b32 v68, v68 offset:2048
    ds_read_b32 v69, v69 offset:2048
    ds_read_b32 v70, v70 offset:2048
    ds_read_b32 v71, v71 offset:2048
    ds_read_b32 v72, v72 offset:2048
    ds_read_b32 v73, v73 offset:2048
    ds_read_b32 v74, v74 offset:2048
    ds_read_b32 v75, v75 offset:2048
    ds_read_b32 v76, v76 offset:2048
    ds_read_b32 v77, v77 offset:2048
    s_cmp_lg_u32 s88, 0
    s_cbranch_scc1 L_w0c
    s_waitcnt vmcnt(15)
L_w0c:
    s_and_b64 exec, s[90:91], 1
    s_and_b32 s93, s2, 3
    s_lshl_b32 s93, s93, 6
    buffer_atomic_add v3, v6, s[40:43], s93 offen
    s_mov_b64 exec, s[86:87]
    s_waitcnt vmcnt(10)
    v_readfirstlane_b32 s95, v4
    v_lshlrev_b32 v4, 16, v4
    v_lshlrev_b32 v98, 16, v48
    v_and_b32 v99, 0xffff0000, v48
    v_lshlrev_b32 v100, 16, v49
    v_and_b32 v101, 0xffff0000, v49
    s_cmp_eq_u32 s95, 0x3f80
    s_cbranch_scc1 L_unit0
    v_mul_f32 v98, v4, v98
    v_mul_f32 v99, v4, v99
    v_mul_f32 v100, v4, v100
    v_mul_f32 v101, v4, v101
    v_cvt_pk_bf16_f32 v48, v98, v99
    v_cvt_pk_bf16_f32 v49, v100, v101
    v_lshlrev_b32 v98, 16, v48
    v_and_b32 v99, 0xffff0000, v48
    v_lshlrev_b32 v100, 16, v49
    v_and_b32 v101, 0xffff0000, v49
L_unit0:
    v_mul_f32 v98, 0.15915494, v98
    v_mul_f32 v99, 0.15915494, v99
    v_mul_f32 v100, 0.15915494, v100
    v_mul_f32 v101, 0.15915494, v101
    v_fract_f32 v98, v98
    v_fract_f32 v99, v99
    v_fract_f32 v100, v100
    v_fract_f32 v101, v101
    v_cos_f32 v98, v98
    v_cos_f32 v99, v99
    v_cos_f32 v100, v100
    v_cos_f32 v101, v101
    s_nop 0
    v_cvt_pkrtz_f16_f32 v48, v98, v99
    v_cvt_pkrtz_f16_f32 v49, v100, v101
    v_add_u32 v48, 0x40004, v48
    v_add_u32 v49, 0x40004, v49
    v_and_b32 v48, 0xbff8bff8, v48
    v_and_b32 v49, 0xbff8bff8, v49
    s_waitcnt vmcnt(9)
    v_lshlrev_b32 v98, 16, v50
    v_and_b32 v99, 0xffff0000, v50
    v_lshlrev_b32 v100, 16, v51
    v_and_b32 v101, 0xffff0000, v51
    s_cmp_eq_u32 s95, 0x3f80
    s_cbranch_scc1 L_unit1
    v_mul_f32 v98, v4, v98
    v_mul_f32 v99, v4, v99
    v_mul_f32 v100, v4, v100
    v_mul_f32 v101, v4, v101
    v_cvt_pk_bf16_f32 v50, v98, v99
    v_cvt_pk_bf16_f32 v51, v100, v101
    v_lshlrev_b32 v98, 16, v50
    v_and_b32 v99, 0xffff0000, v50
    v_lshlrev_b32 v100, 16, v51
    v_and_b32 v101, 0xffff0000, v51
L_unit1:
    v_mul_f32 v98, 0.15915494, v98
    v_mul_f32 v99, 0.15915494, v99
    v_mul_f32 v100, 0.15915494, v100
    v_mul_f32 v101, 0.15915494, v101
    v_fract_f32 v98, v98
    v_fract_f32 v99, v99
    v_fract_f32 v100, v100
    v_fract_f32 v101, v101
    v_cos_f32 v98, v98
    v_cos_f32 v99, v99
    v_cos_f32 v100, v100
    v_cos_f32 v101, v101
    s_nop 0
    v_cvt_pkrtz_f16_f32 v50, v98, v99
    v_cvt_pkrtz_f16_f32 v51, v100, v101
    v_add_u32 v50, 0x40004, v50
    v_add_u32 v51, 0x40004, v51
    v_and_b32 v50, 0xbff8bff8, v50
    v_and_b32 v51, 0xbff8bff8, v51
    s_waitcnt vmcnt(8)
    v_lshlrev_b32 v98, 16, v52
    v_and_b32 v99, 0xffff0000, v52
    v_lshlrev_b32 v100, 16, v53
    v_and_b32 v101, 0xffff0000, v53
    s_cmp_eq_u32 s95, 0x3f80
    s_cbranch_scc1 L_unit2
    v_mul_f32 v98, v4, v98
    v_mul_f32 v99, v4, v99
    v_mul_f32 v100, v4, v100
    v_mul_f32 v101, v4, v101
    v_cvt_pk_bf16_f32 v52, v98, v99
    v_cvt_pk_bf16_f32 v53, v100, v101
    v_lshlrev_b32 v98, 16, v52
    v_and_b32 v99, 0xffff0000, v52
    v_lshlrev_b32 v100, 16, v53
    v_and_b32 v101, 0xffff0000, v53
L_unit2:
    v_mul_f32 v98, 0.15915494, v98
    v_mul_f32 v99, 0.15915494, v99
    v_mul_f32 v100, 0.15915494, v100
    v_mul_f32 v101, 0.15915494, v101
    v_fract_f32 v98, v98
    v_fract_f32 v99, v99
    v_fract_f32 v100, v100
    v_fract_f32 v101, v101
    v_cos_f32 v98, v98
    v_cos_f32 v99, v99
    v_cos_f32 v100, v100
    v_cos_f32 v101, v101
    s_nop 0
    v_cvt_pkrtz_f16_f32 v52, v98, v99
    v_cvt_pkrtz_f16_f32 v53, v100, v101
    v_add_u32 v52, 0x40004, v52
    v_add_u32 v53, 0x40004, v53
    v_and_b32 v52, 0xbff8bff8, v52
    v_and_b32 v53, 0xbff8bff8, v53
    s_waitcnt vmcnt(7)
    v_lshlrev_b32 v98, 16, v54
    v_and_b32 v99, 0xffff0000, v54
    v_lshlrev_b32 v100, 16, v55
    v_and_b32 v101, 0xffff0000, v55
    s_cmp_eq_u32 s95, 0x3f80
    s_cbranch_scc1 L_unit3
    v_mul_f32 v98, v4, v98
    v_mul_f32 v99, v4, v99
    v_mul_f32 v100, v4, v100
    v_mul_f32 v101, v4, v101
    v_cvt_pk_bf16_f32 v54, v98, v99
    v_cvt_pk_bf16_f32 v55, v100, v101
    v_lshlrev_b32 v98, 16, v54
    v_and_b32 v99, 0xffff0000, v54
    v_lshlrev_b32 v100, 16, v55
    v_and_b32 v101, 0xffff0000, v55
L_unit3:
    v_mul_f32 v98, 0.15915494, v98
    v_mul_f32 v99, 0.15915494, v99
    v_mul_f32 v100, 0.15915494, v100
    v_mul_f32 v101, 0.15915494, v101
    v_fract_f32 v98, v98
    v_fract_f32 v99, v99
    v_fract_f32 v100, v100
    v_fract_f32 v101, v101
    v_cos_f32 v98, v98
    v_cos_f32 v99, v99
    v_cos_f32 v100, v100
    v_cos_f32 v101, v101
    s_nop 0
    v_cvt_pkrtz_f16_f32 v54, v98, v99
    v_cvt_pkrtz_f16_f32 v55, v100, v101
    v_add_u32 v54, 0x40004, v54
    v_add_u32 v55, 0x40004, v55
    v_and_b32 v54, 0xbff8bff8, v54
    v_and_b32 v55, 0xbff8bff8, v55
    s_waitcnt vmcnt(6)
    v_lshlrev_b32 v98, 16, v56
    v_and_b32 v99, 0xffff0000, v56
    v_lshlrev_b32 v100, 16, v57
    v_and_b32 v101, 0xffff0000, v57
    s_cmp_eq_u32 s95, 0x3f80
    s_cbranch_scc1 L_unit4
    v_mul_f32 v98, v4, v98
    v_mul_f32 v99, v4, v99
    v_mul_f32 v100, v4, v100
    v_mul_f32 v101, v4, v101
    v_cvt_pk_bf16_f32 v56, v98, v99
    v_cvt_pk_bf16_f32 v57, v100, v101
    v_lshlrev_b32 v98, 16, v56
    v_and_b32 v99, 0xffff0000, v56
    v_lshlrev_b32 v100, 16, v57
    v_and_b32 v101, 0xffff0000, v57
L_unit4:
    v_mul_f32 v98, 0.15915494, v98
    v_mul_f32 v99, 0.15915494, v99
    v_mul_f32 v100, 0.15915494, v100
    v_mul_f32 v101, 0.15915494, v101
    v_fract_f32 v98, v98
    v_fract_f32 v99, v99
    v_fract_f32 v100, v100
    v_fract_f32 v101, v101
    v_cos_f32 v98, v98
    v_cos_f32 v99, v99
    v_cos_f32 v100, v100
    v_cos_f32 v101, v101
    s_nop 0
    v_cvt_pkrtz_f16_f32 v56, v98, v99
    v_cvt_pkrtz_f16_f32 v57, v100, v101
    v_add_u32 v56, 0x40004, v56
    v_add_u32 v57, 0x40004, v57
    v_and_b32 v56, 0xbff8bff8, v56
    v_and_b32 v57, 0xbff8bff8, v57
    s_waitcnt lgkmcnt(0)
    v_mad_u32_u24 v78, v78, 5, v58
    v_and_b32 v58, -4, v78
    v_and_b32 v78, 3, v78
    v_mad_i32_i24 v78, v78, -3, v58
    v_mad_u32_u24 v79, v79, 5, v59
    v_and_b32 v59, -4, v79
    v_and_b32 v79, 3, v79
    v_mad_i32_i24 v79, v79, -3, v59
    v_mad_u32_u24 v80, v80, 5, v60
    v_and_b32 v60, -4, v80
    v_and_b32 v80, 3, v80
    v_mad_i32_i24 v80, v80, -3, v60
    v_mad_u32_u24 v81, v81, 5, v61
    v_and_b32 v61, -4, v81
    v_and_b32 v81, 3, v81
    v_mad_i32_i24 v81, v81, -3, v61
    v_mad_u32_u24 v82, v82, 5, v62
    v_and_b32 v62, -4, v82
    v_and_b32 v82, 3, v82
    v_mad_i32_i24 v82, v82, -3, v62
    v_mad_u32_u24 v83, v83, 5, v63
    v_and_b32 v63, -4, v83
    v_and_b32 v83, 3, v83
    v_mad_i32_i24 v83, v83, -3, v63
    v_mad_u32_u24 v84, v84, 5, v64
    v_and_b32 v64, -4, v84
    v_and_b32 v84, 3, v84
    v_mad_i32_i24 v84, v84, -3, v64
    v_mad_u32_u24 v85, v85, 5, v65
    v_and_b32 v65, -4, v85
    v_and_b32 v85, 3, v85
    v_mad_i32_i24 v85, v85, -3, v65
    v_mad_u32_u24 v86, v86, 5, v66
    v_and_b32 v66, -4, v86
    v_and_b32 v86, 3, v86
    v_mad_i32_i24 v86, v86, -3, v66
    v_mad_u32_u24 v87, v87, 5, v67
    v_and_b32 v67, -4, v87
    v_and_b32 v87, 3, v87
    v_mad_i32_i24 v87, v87, -3, v67
    v_mad_u32_u24 v88, v88, 5, v68
    v_and_b32 v68, -4, v88
    v_and_b32 v88, 3, v88
    v_mad_i32_i24 v88, v88, -3, v68
    v_mad_u32_u24 v89, v89, 5, v69
    v_and_b32 v69, -4, v89
    v_and_b32 v89, 3, v89
    v_mad_i32_i24 v89, v89, -3, v69
    v_mad_u32_u24 v90, v90, 5, v70
    v_and_b32 v70, -4, v90
    v_and_b32 v90, 3, v90
    v_mad_i32_i24 v90, v90, -3, v70
    v_mad_u32_u24 v91, v91, 5, v71
    v_and_b32 v71, -4, v91
    v_and_b32 v91, 3, v91
    v_mad_i32_i24 v91, v91, -3, v71
    v_mad_u32_u24 v92, v92, 5, v72
    v_and_b32 v72, -4, v92
    v_and_b32 v92, 3, v92
    v_mad_i32_i24 v92, v92, -3, v72
    v_mad_u32_u24 v93, v93, 5, v73
    v_and_b32 v73, -4, v93
    v_and_b32 v93, 3, v93
    v_mad_i32_i24 v93, v93, -3, v73
    v_mad_u32_u24 v94, v94, 5, v74
    v_and_b32 v74, -4, v94
    v_and_b32 v94, 3, v94
    v_mad_i32_i24 v94, v94, -3, v74
    v_mad_u32_u24 v95, v95, 5, v75
    v_and_b32 v75, -4, v95
    v_and_b32 v95, 3, v95
    v_mad_i32_i24 v95, v95, -3, v75
    v_mad_u32_u24 v96, v96, 5, v76
    v_and_b32 v76, -4, v96
    v_and_b32 v96, 3, v96
    v_mad_i32_i24 v96, v96, -3, v76
    v_mad_u32_u24 v97, v97, 5, v77
    v_and_b32 v77, -4, v97
    v_and_b32 v97, 3, v97
    v_mad_i32_i24 v97, v97, -3, v77
    s_waitcnt vmcnt(5)
    v_bfe_u32 v98, v8, 4, 6
    v_lshrrev_b32 v102, 15, v28
    v_mad_u32_u24 v98, v102, 40, v98
    v_lshlrev_b32 v28, 16, v28
    v_and_or_b32 v28, v8, s85, v28
    ds_write_b8 v78, v98 offset:16
    v_or_b32_sdwa v28, v28, v48 dst_sel:DWORD dst_unused:UNUSED_PAD src0_sel:DWORD src1_sel:WORD_0
    ds_write_b32 v58, v28
    v_bfe_u32 v99, v9, 4, 6
    v_lshrrev_b32 v102, 15, v29
    v_mad_u32_u24 v99, v102, 40, v99
    v_lshlrev_b32 v29, 16, v29
    v_and_or_b32 v29, v9, s85, v29
    ds_write_b8 v79, v99 offset:16
    v_or_b32_sdwa v29, v29, v48 dst_sel:DWORD dst_unused:UNUSED_PAD src0_sel:DWORD src1_sel:WORD_1
    ds_write_b32 v59, v29
    v_bfe_u32 v100, v10, 4, 6
    v_lshrrev_b32 v102, 15, v30
    v_mad_u32_u24 v100, v102, 40, v100
    v_lshlrev_b32 v30, 16, v30
    v_and_or_b32 v30, v10, s85, v30
    ds_write_b8 v80, v100 offset:16
    v_or_b32_sdwa v30, v30, v49 dst_sel:DWORD dst_unused:UNUSED_PAD src0_sel:DWORD src1_sel:WORD_0
    ds_write_b32 v60, v30
    v_bfe_u32 v101, v11, 4, 6
    v_lshrrev_b32 v102, 15, v31
    v_mad_u32_u24 v101, v102, 40, v101
    v_lshlrev_b32 v31, 16, v31
    v_and_or_b32 v31, v11, s85, v31
    ds_write_b8 v81, v101 offset:16
    v_or_b32_sdwa v31, v31, v49 dst_sel:DWORD dst_unused:UNUSED_PAD src0_sel:DWORD src1_sel:WORD_1
    ds_write_b32 v61, v31
    s_waitcnt vmcnt(4)
    v_bfe_u32 v98, v12, 4, 6
    v_lshrrev_b32 v102, 15, v32
    v_mad_u32_u24 v98, v102, 40, v98
    v_lshlrev_b32 v32, 16, v32
    v_and_or_b32 v32, v12, s85, v32
    ds_write_b8 v82, v98 offset:16
    v_or_b32_sdwa v32, v32, v50 dst_sel:DWORD dst_unused:UNUSED_PAD src0_sel:DWORD src1_sel:WORD_0
    ds_write_b32 v62, v32
    v_bfe_u32 v99, v13, 4, 6
    v_lshrrev_b32 v102, 15, v33
    v_mad_u32_u24 v99, v102, 40, v99
    v_lshlrev_b32 v33, 16, v33
    v_and_or_b32 v33, v13, s85, v33
    ds_write_b8 v83, v99 offset:16
    v_or_b32_sdwa v33, v33, v50 dst_sel:DWORD dst_unused:UNUSED_PAD src0_sel:DWORD src1_sel:WORD_1
    ds_write_b32 v63, v33
    v_bfe_u32 v100, v14, 4, 6
    v_lshrrev_b32 v102, 15, v34
    v_mad_u32_u24 v100, v102, 40, v100
    v_lshlrev_b32 v34, 16, v34
    v_and_or_b32 v34, v14, s85, v34
    ds_write_b8 v84, v100 offset:16
    v_or_b32_sdwa v34, v34, v51 dst_sel:DWORD dst_unused:UNUSED_PAD src0_sel:DWORD src1_sel:WORD_0
    ds_write_b32 v64, v34
    v_bfe_u32 v101, v15, 4, 6
    v_lshrrev_b32 v102, 15, v35
    v_mad_u32_u24 v101, v102, 40, v101
    v_lshlrev_b32 v35, 16, v35
    v_and_or_b32 v35, v15, s85, v35
    ds_write_b8 v85, v101 offset:16
    v_or_b32_sdwa v35, v35, v51 dst_sel:DWORD dst_unused:UNUSED_PAD src0_sel:DWORD src1_sel:WORD_1
    ds_write_b32 v65, v35
    s_waitcnt vmcnt(3)
    v_bfe_u32 v98, v16, 4, 6
    v_lshrrev_b32 v102, 15, v36
    v_mad_u32_u24 v98, v102, 40, v98
    v_lshlrev_b32 v36, 16, v36
    v_and_or_b32 v36, v16, s85, v36
    ds_write_b8 v86, v98 offset:16
    v_or_b32_sdwa v36, v36, v52 dst_sel:DWORD dst_unused:UNUSED_PAD src0_sel:DWORD src1_sel:WORD_0
    ds_write_b32 v66, v36
    v_bfe_u32 v99, v17, 4, 6
    v_lshrrev_b32 v102, 15, v37
    v_mad_u32_u24 v99, v102, 40, v99
    v_lshlrev_b32 v37, 16, v37
    v_and_or_b32 v37, v17, s85, v37
    ds_write_b8 v87, v99 offset:16
    v_or_b32_sdwa v37, v37, v52 dst_sel:DWORD dst_unused:UNUSED_PAD src0_sel:DWORD src1_sel:WORD_1
    ds_write_b32 v67, v37
    v_bfe_u32 v100, v18, 4, 6
    v_lshrrev_b32 v102, 15, v38
    v_mad_u32_u24 v100, v102, 40, v100
    v_lshlrev_b32 v38, 16, v38
    v_and_or_b32 v38, v18, s85, v38
    ds_write_b8 v88, v100 offset:16
    v_or_b32_sdwa v38, v38, v53 dst_sel:DWORD dst_unused:UNUSED_PAD src0_sel:DWORD src1_sel:WORD_0
    ds_write_b32 v68, v38
    v_bfe_u32 v101, v19, 4, 6
    v_lshrrev_b32 v102, 15, v39
    v_mad_u32_u24 v101, v102, 40, v101
    v_lshlrev_b32 v39, 16, v39
    v_and_or_b32 v39, v19, s85, v39
    ds_write_b8 v89, v101 offset:16
    v_or_b32_sdwa v39, v39, v53 dst_sel:DWORD dst_unused:UNUSED_PAD src0_sel:DWORD src1_sel:WORD_1
    ds_write_b32 v69, v39
    s_waitcnt vmcnt(2)
    v_bfe_u32 v98, v20, 4, 6
    v_lshrrev_b32 v102, 15, v40
    v_mad_u32_u24 v98, v102, 40, v98
    v_lshlrev_b32 v40, 16, v40
    v_and_or_b32 v40, v20, s85, v40
    ds_write_b8 v90, v98 offset:16
    v_or_b32_sdwa v40, v40, v54 dst_sel:DWORD dst_unused:UNUSED_PAD src0_sel:DWORD src1_sel:WORD_0
    ds_write_b32 v70, v40
    v_bfe_u32 v99, v21, 4, 6
    v_lshrrev_b32 v102, 15, v41
    v_mad_u32_u24 v99, v102, 40, v99
    v_lshlrev_b32 v41, 16, v41
    v_and_or_b32 v41, v21, s85, v41
    ds_write_b8 v91, v99 offset:16
    v_or_b32_sdwa v41, v41, v54 dst_sel:DWORD dst_unused:UNUSED_PAD src0_sel:DWORD src1_sel:WORD_1
    ds_write_b32 v71, v41
    v_bfe_u32 v100, v22, 4, 6
    v_lshrrev_b32 v102, 15, v42
    v_mad_u32_u24 v100, v102, 40, v100
    v_lshlrev_b32 v42, 16, v42
    v_and_or_b32 v42, v22, s85, v42
    ds_write_b8 v92, v100 offset:16
    v_or_b32_sdwa v42, v42, v55 dst_sel:DWORD dst_unused:UNUSED_PAD src0_sel:DWORD src1_sel:WORD_0
    ds_write_b32 v72, v42
    v_bfe_u32 v101, v23, 4, 6
    v_lshrrev_b32 v102, 15, v43
    v_mad_u32_u24 v101, v102, 40, v101
    v_lshlrev_b32 v43, 16, v43
    v_and_or_b32 v43, v23, s85, v43
    ds_write_b8 v93, v101 offset:16
    v_or_b32_sdwa v43, v43, v55 dst_sel:DWORD dst_unused:UNUSED_PAD src0_sel:DWORD src1_sel:WORD_1
    ds_write_b32 v73, v43
    s_waitcnt vmcnt(1)
    v_bfe_u32 v98, v24, 4, 6
    v_lshrrev_b32 v102, 15, v44
    v_mad_u32_u24 v98, v102, 40, v98
    v_lshlrev_b32 v44, 16, v44
    v_and_or_b32 v44, v24, s85, v44
    ds_write_b8 v94, v98 offset:16
    v_or_b32_sdwa v44, v44, v56 dst_sel:DWORD dst_unused:UNUSED_PAD src0_sel:DWORD src1_sel:WORD_0
    ds_write_b32 v74, v44
    v_bfe_u32 v99, v25, 4, 6
    v_lshrrev_b32 v102, 15, v45
    v_mad_u32_u24 v99, v102, 40, v99
    v_lshlrev_b32 v45, 16, v45
    v_and_or_b32 v45, v25, s85, v45
    ds_write_b8 v95, v99 offset:16
    v_or_b32_sdwa v45, v45, v56 dst_sel:DWORD dst_unused:UNUSED_PAD src0_sel:DWORD src1_sel:WORD_1
    ds_write_b32 v75, v45
    v_bfe_u32 v100, v26, 4, 6
    v_lshrrev_b32 v102, 15, v46
    v_mad_u32_u24 v100, v102, 40, v100
    v_lshlrev_b32 v46, 16, v46
    v_and_or_b32 v46, v26, s85, v46
    ds_write_b8 v96, v100 offset:16
    v_or_b32_sdwa v46, v46, v57 dst_sel:DWORD dst_unused:UNUSED_PAD src0_sel:DWORD src1_sel:WORD_0
    ds_write_b32 v76, v46
    v_bfe_u32 v101, v27, 4, 6
    v_lshrrev_b32 v102, 15, v47
    v_mad_u32_u24 v101, v102, 40, v101
    v_lshlrev_b32 v47, 16, v47
    v_and_or_b32 v47, v27, s85, v47
    ds_write_b8 v97, v101 offset:16
    v_or_b32_sdwa v47, v47, v57 dst_sel:DWORD dst_unused:UNUSED_PAD src0_sel:DWORD src1_sel:WORD_1
    ds_write_b32 v77, v47
    s_mov_b64 exec, -1
    v_add_u32 v5, 92288, v1
    v_mov_b32 v98, v1
    s_waitcnt lgkmcnt(0)
    s_barrier
    ds_read_b128 v[64:67], v5 offset:0
    ds_read_b128 v[68:71], v5 offset:8192
    ds_read_b128 v[72:75], v5 offset:16384
    ds_read_b128 v[76:79], v5 offset:24576
    ds_read_b128 v[80:83], v5 offset:32768
    ds_read_b128 v[84:87], v5 offset:40960
    ds_read_b128 v[88:91], v5 offset:49152
    s_mov_b64 exec, s[90:91]
    ds_write_b128 v98, v[116:119] offset:1024
    ds_write_b128 v98, v[120:123] offset:2048
    s_mov_b64 exec, -1
    s_mov_b32 s94, 0
    s_waitcnt lgkmcnt(8)
    buffer_store_dwordx4 v[64:67], v98, s[16:19], s94 offen sc1
    s_mov_b32 s94, 8192
    s_waitcnt lgkmcnt(7)
    buffer_store_dwordx4 v[68:71], v98, s[16:19], s94 offen sc1
    s_mov_b32 s94, 16384
    s_waitcnt lgkmcnt(6)
    buffer_store_dwordx4 v[72:75], v98, s[16:19], s94 offen sc1
    s_mov_b32 s94, 24576
    s_waitcnt lgkmcnt(5)
    buffer_store_dwordx4 v[76:79], v98, s[16:19], s94 offen sc1
    s_mov_b32 s94, 32768
    s_waitcnt lgkmcnt(4)
    buffer_store_dwordx4 v[80:83], v98, s[16:19], s94 offen sc1
    s_mov_b32 s94, 40960
    s_waitcnt lgkmcnt(3)
    buffer_store_dwordx4 v[84:87], v98, s[16:19], s94 offen sc1
    s_mov_b32 s94, 49152
    s_waitcnt lgkmcnt(2)
    buffer_store_dwordx4 v[88:91], v98, s[16:19], s94 offen sc1
    s_cmp_lg_u32 s88, 7
    s_cbranch_scc1 L_nox
    s_mov_b64 exec, 15
    buffer_load_dword v124, v125, s[40:43], 0 offen sc1
    s_mov_b64 exec, -1
L_nox:
    v_lshrrev_b32 v16, 6, v0
    v_and_b32 v1, 63, v0
    v_and_b32 v17, 31, v0
    v_lshl_add_u32 v18, v17, 3, v16
    v_lshlrev_b32 v102, 10, v18
    s_lshl_b32 s64, s3, 2
    v_mul_u32_u24 v103, 53888, v18
    v_and_b32 v22, 15, v1
    v_lshrrev_b32 v23, 4, v1
    v_mul_u32_u24 v2, 20, v22
    v_lshlrev_b32 v105, 7, v16
    v_add_u32 v105, 3072, v105
    v_lshl_add_u32 v106, v23, 4, v105
    v_mul_u32_u24 v24, 80, v16
    v_add_u32 v24, v24, v22
    v_lshlrev_b32 v14, 5, v24
    v_lshl_add_u32 v14, v23, 3, v14
    v_cmp_gt_u32 vcc, 561, v24
    v_mov_b32 v25, 0x7fffff00
    v_lshlrev_b32 v107, 1, v24
    v_cndmask_b32 v15, v25, v14, vcc
    v_mov_b32 v4, 0
    v_mov_b32 v3, 4
    v_lshrrev_b32 v21, 1, v1
    v_lshlrev_b32 v5, 2, v21
    v_and_b32 v6, 1, v1
    v_lshlrev_b32 v6, 4, v6
    v_bfe_u32 v22, v21, 2, 1
    v_bfe_u32 v23, v21, 4, 1
    v_lshl_add_u32 v22, v23, 1, v22
    v_and_b32 v23, 3, v21
    v_bfe_u32 v24, v21, 3, 1
    v_lshl_add_u32 v23, v24, 2, v23
    v_lshlrev_b32 v23, 1, v23
    v_lshl_add_u32 v7, v22, 8, v23
    v_lshlrev_b32 v24, 10, v16
    v_add_u32 v24, 4096, v24
    v_add_u32 v7, v7, v24
    v_lshl_add_u32 v8, v1, 4, v24
    v_bfe_u32 v22, v1, 4, 1
    v_bfe_u32 v23, v1, 5, 1
    v_lshlrev_b32 v23, 4, v23
    v_lshl_add_u32 v22, v22, 2, v23
    v_bfe_u32 v23, v1, 2, 2
    v_add_u32 v22, v22, v23
    v_and_b32 v23, 3, v1
    v_lshlrev_b32 v23, 3, v23
    v_lshl_add_u32 v9, v22, 5, v23
    v_lshlrev_b32 v24, 12, v16
    v_add_u32 v24, 92288, v24
    v_add_u32 v9, v9, v24
    v_mul_u32_u24 v22, 52, v1
    v_lshrrev_b32 v22, 8, v22
    v_mul_u32_u24 v24, 5, v22
    v_sub_u32 v24, v1, v24
    s_lshr_b32 s66, s3, 5
    s_mul_i32 s66, s66, 3
    s_lshr_b32 s66, 6885924, s66
    s_and_b32 s66, s66, 7
    v_add_u32 v22, s66, v22
    v_subrev_u32 v23, 5, v22
    v_min_u32 v22, v22, v23
    v_lshrrev_b32 v13, 1, v22
    v_lshlrev_b32 v13, 21, v13
    v_mul_u32_u24 v22, 40, v22
    v_mul_u32_u24 v23, 5, v16
    v_add3_u32 v22, v22, v23, v24
    v_add_u32 v22, 1, v22
    v_lshlrev_b32 v11, 2, v22
    v_mul_u32_u24 v10, 384, v22
    v_add_u32 v10, 14976, v10
    v_cmp_lt_u32 vcc, 24, v1
    v_mov_b32 v24, 92160
    s_nop 0
    v_cndmask_b32 v10, v10, v24, vcc
    v_cndmask_b32 v13, v13, v4, vcc
    v_cndmask_b32 v11, v11, v4, vcc
    v_add_u32 v22, 1, v1
    v_mul_u32_u24 v108, 384, v22
    v_add_u32 v108, 14976, v108
    v_add_u32 v22, 65, v1
    v_mul_u32_u24 v109, 384, v22
    v_add_u32 v109, 14976, v109
    v_add_u32 v22, 129, v1
    v_mul_u32_u24 v110, 384, v22
    v_add_u32 v110, 14976, v110
    v_add_u32 v22, 193, v1
    v_mul_u32_u24 v111, 384, v22
    v_add_u32 v111, 14976, v111
    v_mul_u32_u24 v16, 384, v0
    v_add_u32 v16, 14976, v16
    v_mov_b32 v17, 12288
    v_cmp_eq_u32 vcc, 0, v0
    v_mov_b32 v18, 0
    v_lshlrev_b32 v19, 2, v0
    v_cndmask_b32 v16, v16, v17, vcc
    v_cmp_lt_u32 vcc, 200, v0
    s_nop 1
    v_cndmask_b32 v16, v16, v18, vcc
    v_cmp_gt_u32 vcc, 256, v0
    s_and_saveexec_b64 s[66:67], vcc
    ds_write_b32 v19, v16 offset:0
    s_mov_b64 exec, s[66:67]
    v_lshlrev_b32 v20, 4, v0
    v_mov_b32 v248, 0
    v_mov_b32 v249, 0
    v_mov_b32 v250, 0
    v_mov_b32 v251, 0
    v_add_u32 v20, 4096, v20
    v_add_u32 v21, 65536, v20
    v_cmp_gt_u32 vcc, 392, v0
    ds_write_b128 v20, v[248:251] offset:0
    ds_write_b128 v20, v[248:251] offset:8192
    ds_write_b128 v20, v[248:251] offset:16384
    ds_write_b128 v20, v[248:251] offset:24576
    ds_write_b128 v20, v[248:251] offset:32768
    ds_write_b128 v20, v[248:251] offset:40960
    ds_write_b128 v20, v[248:251] offset:49152
    ds_write_b128 v20, v[248:251] offset:57344
    ds_write_b128 v21, v[248:251] offset:0
    ds_write_b128 v21, v[248:251] offset:8192
    s_mov_b64 exec, vcc
    ds_write_b128 v21, v[248:251] offset:16384
    s_mov_b64 exec, -1
    v_mov_b32 v132, 0
    v_mov_b32 v133, 0
    v_mov_b32 v134, 0
    v_mov_b32 v135, 0
    v_mov_b32 v136, 0
    v_mov_b32 v137, 0
    v_mov_b32 v138, 0
    v_mov_b32 v139, 0
    v_mov_b32 v140, 0
    v_mov_b32 v141, 0
    v_mov_b32 v142, 0
    v_mov_b32 v143, 0
    v_mov_b32 v144, 0
    v_mov_b32 v145, 0
    v_mov_b32 v146, 0
    v_mov_b32 v147, 0
    v_mov_b32 v148, 0
    v_mov_b32 v149, 0
    v_mov_b32 v150, 0
    v_mov_b32 v151, 0
    s_mov_b32 s60, -1
    s_mov_b32 s61, 0
    s_mov_b32 s62, 0
    s_mov_b32 s79, 0
    s_mov_b64 s[74:75], -1
    s_mul_i32 s72, s3, 1250
    s_mul_i32 s73, s3, 20000
    s_mul_i32 s76, s88, 2736
    s_add_u32 s76, s76, 125056
    s_mul_i32 s66, s88, 2560
    v_lshlrev_b32 v126, 4, v1
    v_add_u32 v126, s66, v126
    v_subrev_u32 v127, s66, v14
    v_add_u32 v127, s76, v127
    s_mul_i32 s66, s88, 160
    v_subrev_u32 v128, s66, v107
    v_lshlrev_b32 v107, 2, v1
    v_add_u32 v107, s66, v107
    s_and_b32 s66, s72, 2
    s_and_b32 s72, s72, -4
    s_add_u32 s66, s66, s76
    v_add_u32 v128, s66, v128
    s_waitcnt vmcnt(0) lgkmcnt(0)
    s_cmp_lg_u32 s88, 7
    s_cbranch_scc1 L_ctr_ok
L_ctr:
    v_readlane_b32 s94, v124, 0
    v_readlane_b32 s95, v124, 1
    s_add_u32 s94, s94, s95
    v_readlane_b32 s95, v124, 2
    s_add_u32 s94, s94, s95
    v_readlane_b32 s95, v124, 3
    s_add_u32 s94, s94, s95
    s_cmp_ge_u32 s94, 256
    s_cbranch_scc1 L_ctr_ok
    s_add_u32 s89, s89, 1
    s_cmp_gt_u32 s89, 1048576
    s_cbranch_scc1 L_end
    s_mov_b64 exec, 15
    buffer_load_dword v124, v125, s[40:43], 0 offen sc1
    s_mov_b64 exec, -1
    s_waitcnt vmcnt(0)
    s_branch L_ctr
L_ctr_ok:
    s_mov_b32 s89, 0
    s_barrier
    s_mov_b64 exec, s[90:91]
    buffer_store_dwordx4 v[112:115], v98, s[20:23], s92 offen sc1
    s_branch L_idle3
L_top0:
    s_mov_b32 exec_lo, s60
    s_mov_b32 exec_hi, 0
    s_cbranch_execz L_nowait0
    s_waitcnt vmcnt(8)
L_nowait0:
    v_cmp_gt_i32 vcc, 0, v104
    s_and_b32 s66, s60, vcc_lo
    s_andn2_b32 s60, s60, s66
    s_mov_b32 exec_lo, s66
    v_and_b32 v16, 0xfff, v104
    v_bfe_u32 v17, v104, 12, 12
    v_mad_u32_u24 v100, v16, 20, v103
    v_mul_u32_u24 v101, 20, v17
    s_or_b32 s61, s61, s66
    s_cbranch_scc1 L_some0
    s_cmp_eq_u32 s62, 0
    s_cbranch_scc1 L_idle
    s_cmp_eq_u32 s60, 0
    s_cbranch_scc1 L_final0
L_take0:
    s_mov_b32 exec_lo, 0xffff
    v_lshl_add_u32 v19, v1, 2, v105
    ds_write_b32 v19, v4 offset:64
    s_mov_b32 exec_lo, s61
    v_mbcnt_lo_u32_b32 v16, s61, 0
    v_cmp_gt_u32 vcc, 16, v16
    s_and_b32 s63, s61, vcc_lo
    s_mov_b32 exec_lo, s63
    v_and_b32 v18, 3, v16
    v_lshrrev_b32 v16, 2, v16
    v_min_u32 v17, 320, v101
    v_lshl_add_u32 v16, v18, 2, v16
    v_sub_u32 v101, v101, v17
    v_lshl_add_u32 v16, v16, 2, v105
    ds_write_b32 v16, v100
    ds_write_b32 v16, v17 offset:64
    v_cmp_lt_u32 vcc, 0, v101
    v_add_u32 v100, 320, v100
    s_andn2_b32 s61, s61, s63
    s_and_b32 s66, s63, vcc_lo
    s_or_b32 s61, s61, s66
    s_mov_b64 exec, -1
    ds_read_b128 v[88:91], v106
    ds_read_b128 v[92:95], v106 offset:64
    s_cmp_eq_u32 s62, 0
    s_mov_b32 s62, s63
    s_waitcnt lgkmcnt(0)
    s_cbranch_scc1 L_only0
    s_mov_b32 exec_lo, s60
    s_mov_b32 exec_hi, 0
    buffer_load_dword v104, v102, s[20:23], s64 offen sc1
    s_mov_b64 exec, -1
    v_add_u32 v37, v88, v2
    v_cmp_lt_u32 s[44:45], v2, v92
    s_mov_b64 exec, s[44:45]
    buffer_load_dwordx4 v[32:35], v37, s[24:27], 0 offen
    buffer_load_dword v36, v37, s[24:27], 0 offen offset:16
    s_waitcnt vmcnt(9)
    s_mov_b64 exec, s[52:53]
    v_lshlrev_b32_sdwa v80, 2, v60 dst_sel:DWORD dst_unused:UNUSED_PAD src0_sel:DWORD src1_sel:BYTE_0
    ds_add_rtn_u32 v80, v80, v3 offset:0
    v_lshlrev_b32_sdwa v81, 2, v60 dst_sel:DWORD dst_unused:UNUSED_PAD src0_sel:DWORD src1_sel:BYTE_1
    ds_add_rtn_u32 v81, v81, v3 offset:0
    v_lshlrev_b32_sdwa v82, 2, v60 dst_sel:DWORD dst_unused:UNUSED_PAD src0_sel:DWORD src1_sel:BYTE_2
    ds_add_rtn_u32 v82, v82, v3 offset:0
    v_lshlrev_b32_sdwa v83, 2, v60 dst_sel:DWORD dst_unused:UNUSED_PAD src0_sel:DWORD src1_sel:BYTE_3
    ds_add_rtn_u32 v83, v83, v3 offset:0
    s_mov_b64 exec, -1
    v_add_u32 v43, v89, v2
    v_cmp_lt_u32 s[46:47], v2, v93
    s_mov_b64 exec, s[46:47]
    buffer_load_dwordx4 v[38:41], v43, s[24:27], 0 offen
    buffer_load_dword v42, v43, s[24:27], 0 offen offset:16
    s_waitcnt vmcnt(9)
    s_mov_b64 exec, s[54:55]
    v_lshlrev_b32_sdwa v84, 2, v66 dst_sel:DWORD dst_unused:UNUSED_PAD src0_sel:DWORD src1_sel:BYTE_0
    ds_add_rtn_u32 v84, v84, v3 offset:0
    v_lshlrev_b32_sdwa v85, 2, v66 dst_sel:DWORD dst_unused:UNUSED_PAD src0_sel:DWORD src1_sel:BYTE_1
    ds_add_rtn_u32 v85, v85, v3 offset:0
    v_lshlrev_b32_sdwa v86, 2, v66 dst_sel:DWORD dst_unused:UNUSED_PAD src0_sel:DWORD src1_sel:BYTE_2
    ds_add_rtn_u32 v86, v86, v3 offset:0
    v_lshlrev_b32_sdwa v87, 2, v66 dst_sel:DWORD dst_unused:UNUSED_PAD src0_sel:DWORD src1_sel:BYTE_3
    ds_add_rtn_u32 v87, v87, v3 offset:0
    s_waitcnt lgkmcnt(4)
    s_mov_b64 exec, s[52:53]
    ds_write_b32 v80, v56
    ds_write_b32 v81, v57
    ds_write_b32 v82, v58
    ds_write_b32 v83, v59
    s_mov_b64 exec, -1
    v_add_u32 v49, v90, v2
    v_cmp_lt_u32 s[48:49], v2, v94
    s_mov_b64 exec, s[48:49]
    buffer_load_dwordx4 v[44:47], v49, s[24:27], 0 offen
    buffer_load_dword v48, v49, s[24:27], 0 offen offset:16
    s_waitcnt vmcnt(9)
    s_mov_b64 exec, s[56:57]
    v_lshlrev_b32_sdwa v80, 2, v72 dst_sel:DWORD dst_unused:UNUSED_PAD src0_sel:DWORD src1_sel:BYTE_0
    ds_add_rtn_u32 v80, v80, v3 offset:0
    v_lshlrev_b32_sdwa v81, 2, v72 dst_sel:DWORD dst_unused:UNUSED_PAD src0_sel:DWORD src1_sel:BYTE_1
    ds_add_rtn_u32 v81, v81, v3 offset:0
    v_lshlrev_b32_sdwa v82, 2, v72 dst_sel:DWORD dst_unused:UNUSED_PAD src0_sel:DWORD src1_sel:BYTE_2
    ds_add_rtn_u32 v82, v82, v3 offset:0
    v_lshlrev_b32_sdwa v83, 2, v72 dst_sel:DWORD dst_unused:UNUSED_PAD src0_sel:DWORD src1_sel:BYTE_3
    ds_add_rtn_u32 v83, v83, v3 offset:0
    s_waitcnt lgkmcnt(8)
    s_mov_b64 exec, s[54:55]
    ds_write_b32 v84, v62
    ds_write_b32 v85, v63
    ds_write_b32 v86, v64
    ds_write_b32 v87, v65
    s_mov_b64 exec, -1
    v_add_u32 v55, v91, v2
    v_cmp_lt_u32 s[50:51], v2, v95
    s_mov_b64 exec, s[50:51]
    buffer_load_dwordx4 v[50:53], v55, s[24:27], 0 offen
    buffer_load_dword v54, v55, s[24:27], 0 offen offset:16
    s_waitcnt vmcnt(9)
    s_mov_b64 exec, s[58:59]
    v_lshlrev_b32_sdwa v84, 2, v78 dst_sel:DWORD dst_unused:UNUSED_PAD src0_sel:DWORD src1_sel:BYTE_0
    ds_add_rtn_u32 v84, v84, v3 offset:0
    v_lshlrev_b32_sdwa v85, 2, v78 dst_sel:DWORD dst_unused:UNUSED_PAD src0_sel:DWORD src1_sel:BYTE_1
    ds_add_rtn_u32 v85, v85, v3 offset:0
    v_lshlrev_b32_sdwa v86, 2, v78 dst_sel:DWORD dst_unused:UNUSED_PAD src0_sel:DWORD src1_sel:BYTE_2
    ds_add_rtn_u32 v86, v86, v3 offset:0
    v_lshlrev_b32_sdwa v87, 2, v78 dst_sel:DWORD dst_unused:UNUSED_PAD src0_sel:DWORD src1_sel:BYTE_3
    ds_add_rtn_u32 v87, v87, v3 offset:0
    s_waitcnt lgkmcnt(8)
    s_mov_b64 exec, s[56:57]
    ds_write_b32 v80, v68
    ds_write_b32 v81, v69
    ds_write_b32 v82, v70
    ds_write_b32 v83, v71
    s_waitcnt lgkmcnt(4)
    s_mov_b64 exec, s[58:59]
    ds_write_b32 v84, v74
    ds_write_b32 v85, v75
    ds_write_b32 v86, v76
    ds_write_b32 v87, v77
    s_branch L_top1
L_top1:
    s_mov_b32 exec_lo, s60
    s_mov_b32 exec_hi, 0
    s_cbranch_execz L_nowait1
    s_waitcnt vmcnt(8)
L_nowait1:
    v_cmp_gt_i32 vcc, 0, v104
    s_and_b32 s66, s60, vcc_lo
    s_andn2_b32 s60, s60, s66
    s_mov_b32 exec_lo, s66
    v_and_b32 v16, 0xfff, v104
    v_bfe_u32 v17, v104, 12, 12
    v_mad_u32_u24 v100, v16, 20, v103
    v_mul_u32_u24 v101, 20, v17
    s_or_b32 s61, s61, s66
    s_cbranch_scc1 L_some1
    s_cmp_eq_u32 s62, 0
    s_cbranch_scc1 L_idle
    s_cmp_eq_u32 s60, 0
    s_cbranch_scc1 L_final1
L_take1:
    s_mov_b32 exec_lo, 0xffff
    v_lshl_add_u32 v19, v1, 2, v105
    ds_write_b32 v19, v4 offset:64
    s_mov_b32 exec_lo, s61
    v_mbcnt_lo_u32_b32 v16, s61, 0
    v_cmp_gt_u32 vcc, 16, v16
    s_and_b32 s63, s61, vcc_lo
    s_mov_b32 exec_lo, s63
    v_and_b32 v18, 3, v16
    v_lshrrev_b32 v16, 2, v16
    v_min_u32 v17, 320, v101
    v_lshl_add_u32 v16, v18, 2, v16
    v_sub_u32 v101, v101, v17
    v_lshl_add_u32 v16, v16, 2, v105
    ds_write_b32 v16, v100
    ds_write_b32 v16, v17 offset:64
    v_cmp_lt_u32 vcc, 0, v101
    v_add_u32 v100, 320, v100
    s_andn2_b32 s61, s61, s63
    s_and_b32 s66, s63, vcc_lo
    s_or_b32 s61, s61, s66
    s_mov_b64 exec, -1
    ds_read_b128 v[88:91], v106
    ds_read_b128 v[92:95], v106 offset:64
    s_cmp_eq_u32 s62, 0
    s_mov_b32 s62, s63
    s_waitcnt lgkmcnt(0)
    s_cbranch_scc1 L_only1
    s_mov_b32 exec_lo, s60
    s_mov_b32 exec_hi, 0
    buffer_load_dword v104, v102, s[20:23], s64 offen sc1
    s_mov_b64 exec, -1
    v_add_u32 v61, v88, v2
    v_cmp_lt_u32 s[52:53], v2, v92
    s_mov_b64 exec, s[52:53]
    buffer_load_dwordx4 v[56:59], v61, s[24:27], 0 offen
    buffer_load_dword v60, v61, s[24:27], 0 offen offset:16
    s_waitcnt vmcnt(9)
    s_mov_b64 exec, s[44:45]
    v_lshlrev_b32_sdwa v80, 2, v36 dst_sel:DWORD dst_unused:UNUSED_PAD src0_sel:DWORD src1_sel:BYTE_0
    ds_add_rtn_u32 v80, v80, v3 offset:0
    v_lshlrev_b32_sdwa v81, 2, v36 dst_sel:DWORD dst_unused:UNUSED_PAD src0_sel:DWORD src1_sel:BYTE_1
    ds_add_rtn_u32 v81, v81, v3 offset:0
    v_lshlrev_b32_sdwa v82, 2, v36 dst_sel:DWORD dst_unused:UNUSED_PAD src0_sel:DWORD src1_sel:BYTE_2
    ds_add_rtn_u32 v82, v82, v3 offset:0
    v_lshlrev_b32_sdwa v83, 2, v36 dst_sel:DWORD dst_unused:UNUSED_PAD src0_sel:DWORD src1_sel:BYTE_3
    ds_add_rtn_u32 v83, v83, v3 offset:0
    s_mov_b64 exec, -1
    v_add_u32 v67, v89, v2
    v_cmp_lt_u32 s[54:55], v2, v93
    s_mov_b64 exec, s[54:55]
    buffer_load_dwordx4 v[62:65], v67, s[24:27], 0 offen
    buffer_load_dword v66, v67, s[24:27], 0 offen offset:16
    s_waitcnt vmcnt(9)
    s_mov_b64 exec, s[46:47]
    v_lshlrev_b32_sdwa v84, 2, v42 dst_sel:DWORD dst_unused:UNUSED_PAD src0_sel:DWORD src1_sel:BYTE_0
    ds_add_rtn_u32 v84, v84, v3 offset:0
    v_lshlrev_b32_sdwa v85, 2, v42 dst_sel:DWORD dst_unused:UNUSED_PAD src0_sel:DWORD src1_sel:BYTE_1
    ds_add_rtn_u32 v85, v85, v3 offset:0
    v_lshlrev_b32_sdwa v86, 2, v42 dst_sel:DWORD dst_unused:UNUSED_PAD src0_sel:DWORD src1_sel:BYTE_2
    ds_add_rtn_u32 v86, v86, v3 offset:0
    v_lshlrev_b32_sdwa v87, 2, v42 dst_sel:DWORD dst_unused:UNUSED_PAD src0_sel:DWORD src1_sel:BYTE_3
    ds_add_rtn_u32 v87, v87, v3 offset:0
    s_waitcnt lgkmcnt(4)
    s_mov_b64 exec, s[44:45]
    ds_write_b32 v80, v32
    ds_write_b32 v81, v33
    ds_write_b32 v82, v34
    ds_write_b32 v83, v35
    s_mov_b64 exec, -1
    v_add_u32 v73, v90, v2
    v_cmp_lt_u32 s[56:57], v2, v94
    s_mov_b64 exec, s[56:57]
    buffer_load_dwordx4 v[68:71], v73, s[24:27], 0 offen
    buffer_load_dword v72, v73, s[24:27], 0 offen offset:16
    s_waitcnt vmcnt(9)
    s_mov_b64 exec, s[48:49]
    v_lshlrev_b32_sdwa v80, 2, v48 dst_sel:DWORD dst_unused:UNUSED_PAD src0_sel:DWORD src1_sel:BYTE_0
    ds_add_rtn_u32 v80, v80, v3 offset:0
    v_lshlrev_b32_sdwa v81, 2, v48 dst_sel:DWORD dst_unused:UNUSED_PAD src0_sel:DWORD src1_sel:BYTE_1
    ds_add_rtn_u32 v81, v81, v3 offset:0
    v_lshlrev_b32_sdwa v82, 2, v48 dst_sel:DWORD dst_unused:UNUSED_PAD src0_sel:DWORD src1_sel:BYTE_2
    ds_add_rtn_u32 v82, v82, v3 offset:0
    v_lshlrev_b32_sdwa v83, 2, v48 dst_sel:DWORD dst_unused:UNUSED_PAD src0_sel:DWORD src1_sel:BYTE_3
    ds_add_rtn_u32 v83, v83, v3 offset:0
    s_waitcnt lgkmcnt(8)
    s_mov_b64 exec, s[46:47]
    ds_write_b32 v84, v38
    ds_write_b32 v85, v39
    ds_write_b32 v86, v40
    ds_write_b32 v87, v41
    s_mov_b64 exec, -1
    v_add_u32 v79, v91, v2
    v_cmp_lt_u32 s[58:59], v2, v95
    s_mov_b64 exec, s[58:59]
    buffer_load_dwordx4 v[74:77], v79, s[24:27], 0 offen
    buffer_load_dword v78, v79, s[24:27], 0 offen offset:16
    s_waitcnt vmcnt(9)
    s_mov_b64 exec, s[50:51]
    v_lshlrev_b32_sdwa v84, 2, v54 dst_sel:DWORD dst_unused:UNUSED_PAD src0_sel:DWORD src1_sel:BYTE_0
    ds_add_rtn_u32 v84, v84, v3 offset:0
    v_lshlrev_b32_sdwa v85, 2, v54 dst_sel:DWORD dst_unused:UNUSED_PAD src0_sel:DWORD src1_sel:BYTE_1
    ds_add_rtn_u32 v85, v85, v3 offset:0
    v_lshlrev_b32_sdwa v86, 2, v54 dst_sel:DWORD dst_unused:UNUSED_PAD src0_sel:DWORD src1_sel:BYTE_2
    ds_add_rtn_u32 v86, v86, v3 offset:0
    v_lshlrev_b32_sdwa v87, 2, v54 dst_sel:DWORD dst_unused:UNUSED_PAD src0_sel:DWORD src1_sel:BYTE_3
    ds_add_rtn_u32 v87, v87, v3 offset:0
    s_waitcnt lgkmcnt(8)
    s_mov_b64 exec, s[48:49]
    ds_write_b32 v80, v44
    ds_write_b32 v81, v45
    ds_write_b32 v82, v46
    ds_write_b32 v83, v47
    s_waitcnt lgkmcnt(4)
    s_mov_b64 exec, s[50:51]
    ds_write_b32 v84, v50
    ds_write_b32 v85, v51
    ds_write_b32 v86, v52
    ds_write_b32 v87, v53
    s_branch L_top0
L_some0:
    s_cmp_lg_u32 s62, 0
    s_cbranch_scc1 L_take0
    s_cmp_eq_u32 s60, 0
    s_cbranch_scc1 L_take0
    s_bcnt1_i32_b32 s66, s61
    s_cmp_ge_u32 s66, 16
    s_cbranch_scc1 L_take0
    s_branch L_idle2
L_some1:
    s_cmp_lg_u32 s62, 0
    s_cbranch_scc1 L_take1
    s_cmp_eq_u32 s60, 0
    s_cbranch_scc1 L_take1
    s_bcnt1_i32_b32 s66, s61
    s_cmp_ge_u32 s66, 16
    s_cbranch_scc1 L_take1
    s_branch L_idle2
L_only0:
    s_mov_b32 exec_lo, s60
    s_mov_b32 exec_hi, 0
    buffer_load_dword v104, v102, s[20:23], s64 offen sc1
    s_mov_b64 exec, -1
    v_add_u32 v37, v88, v2
    v_cmp_lt_u32 s[44:45], v2, v92
    s_mov_b64 exec, s[44:45]
    buffer_load_dwordx4 v[32:35], v37, s[24:27], 0 offen
    buffer_load_dword v36, v37, s[24:27], 0 offen offset:16
    s_mov_b64 exec, -1
    v_add_u32 v43, v89, v2
    v_cmp_lt_u32 s[46:47], v2, v93
    s_mov_b64 exec, s[46:47]
    buffer_load_dwordx4 v[38:41], v43, s[24:27], 0 offen
    buffer_load_dword v42, v43, s[24:27], 0 offen offset:16
    s_mov_b64 exec, -1
    v_add_u32 v49, v90, v2
    v_cmp_lt_u32 s[48:49], v2, v94
    s_mov_b64 exec, s[48:49]
    buffer_load_dwordx4 v[44:47], v49, s[24:27], 0 offen
    buffer_load_dword v48, v49, s[24:27], 0 offen offset:16
    s_mov_b64 exec, -1
    v_add_u32 v55, v91, v2
    v_cmp_lt_u32 s[50:51], v2, v95
    s_mov_b64 exec, s[50:51]
    buffer_load_dwordx4 v[50:53], v55, s[24:27], 0 offen
    buffer_load_dword v54, v55, s[24:27], 0 offen offset:16
    s_branch L_top1
L_only1:
    s_mov_b32 exec_lo, s60
    s_mov_b32 exec_hi, 0
    buffer_load_dword v104, v102, s[20:23], s64 offen sc1
    s_mov_b64 exec, -1
    v_add_u32 v61, v88, v2
    v_cmp_lt_u32 s[52:53], v2, v92
    s_mov_b64 exec, s[52:53]
    buffer_load_dwordx4 v[56:59], v61, s[24:27], 0 offen
    buffer_load_dword v60, v61, s[24:27], 0 offen offset:16
    s_mov_b64 exec, -1
    v_add_u32 v67, v89, v2
    v_cmp_lt_u32 s[54:55], v2, v93
    s_mov_b64 exec, s[54:55]
    buffer_load_dwordx4 v[62:65], v67, s[24:27], 0 offen
    buffer_load_dword v66, v67, s[24:27], 0 offen offset:16
    s_mov_b64 exec, -1
    v_add_u32 v73, v90, v2
    v_cmp_lt_u32 s[56:57], v2, v94
    s_mov_b64 exec, s[56:57]
    buffer_load_dwordx4 v[68:71], v73, s[24:27], 0 offen
    buffer_load_dword v72, v73, s[24:27], 0 offen offset:16
    s_mov_b64 exec, -1
    v_add_u32 v79, v91, v2
    v_cmp_lt_u32 s[58:59], v2, v95
    s_mov_b64 exec, s[58:59]
    buffer_load_dwordx4 v[74:77], v79, s[24:27], 0 offen
    buffer_load_dword v78, v79, s[24:27], 0 offen offset:16
    s_branch L_top0
L_final0:
    s_mov_b64 exec, s[74:75]
    s_add_u32 m0, s76, 0
    s_nop 0
    buffer_load_dwordx4 v126, s[28:31], s73 offen offset:0 lds
    s_add_u32 m0, s76, 0
    s_nop 0
    buffer_load_dwordx4 v126, s[28:31], s73 offen offset:1024 lds
    s_add_u32 m0, s76, 0
    s_mov_b32 exec_hi, 0
    buffer_load_dwordx4 v126, s[28:31], s73 offen offset:2048 lds
    s_add_u32 m0, s76, 2560
    s_and_b32 exec_hi, s75, 0x1ff
    buffer_load_dword v107, s[36:39], s72 offen lds
    s_mov_b64 s[74:75], 0
    s_waitcnt vmcnt(10)
    s_mov_b64 exec, s[52:53]
    v_lshlrev_b32_sdwa v80, 2, v60 dst_sel:DWORD dst_unused:UNUSED_PAD src0_sel:DWORD src1_sel:BYTE_0
    ds_add_rtn_u32 v80, v80, v3 offset:0
    v_lshlrev_b32_sdwa v81, 2, v60 dst_sel:DWORD dst_unused:UNUSED_PAD src0_sel:DWORD src1_sel:BYTE_1
    ds_add_rtn_u32 v81, v81, v3 offset:0
    v_lshlrev_b32_sdwa v82, 2, v60 dst_sel:DWORD dst_unused:UNUSED_PAD src0_sel:DWORD src1_sel:BYTE_2
    ds_add_rtn_u32 v82, v82, v3 offset:0
    v_lshlrev_b32_sdwa v83, 2, v60 dst_sel:DWORD dst_unused:UNUSED_PAD src0_sel:DWORD src1_sel:BYTE_3
    ds_add_rtn_u32 v83, v83, v3 offset:0
    s_waitcnt vmcnt(8)
    s_mov_b64 exec, s[54:55]
    v_lshlrev_b32_sdwa v84, 2, v66 dst_sel:DWORD dst_unused:UNUSED_PAD src0_sel:DWORD src1_sel:BYTE_0
    ds_add_rtn_u32 v84, v84, v3 offset:0
    v_lshlrev_b32_sdwa v85, 2, v66 dst_sel:DWORD dst_unused:UNUSED_PAD src0_sel:DWORD src1_sel:BYTE_1
    ds_add_rtn_u32 v85, v85, v3 offset:0
    v_lshlrev_b32_sdwa v86, 2, v66 dst_sel:DWORD dst_unused:UNUSED_PAD src0_sel:DWORD src1_sel:BYTE_2
    ds_add_rtn_u32 v86, v86, v3 offset:0
    v_lshlrev_b32_sdwa v87, 2, v66 dst_sel:DWORD dst_unused:UNUSED_PAD src0_sel:DWORD src1_sel:BYTE_3
    ds_add_rtn_u32 v87, v87, v3 offset:0
    s_waitcnt lgkmcnt(4)
    s_mov_b64 exec, s[52:53]
    ds_write_b32 v80, v56
    ds_write_b32 v81, v57
    ds_write_b32 v82, v58
    ds_write_b32 v83, v59
    s_waitcnt vmcnt(6)
    s_mov_b64 exec, s[56:57]
    v_lshlrev_b32_sdwa v80, 2, v72 dst_sel:DWORD dst_unused:UNUSED_PAD src0_sel:DWORD src1_sel:BYTE_0
    ds_add_rtn_u32 v80, v80, v3 offset:0
    v_lshlrev_b32_sdwa v81, 2, v72 dst_sel:DWORD dst_unused:UNUSED_PAD src0_sel:DWORD src1_sel:BYTE_1
    ds_add_rtn_u32 v81, v81, v3 offset:0
    v_lshlrev_b32_sdwa v82, 2, v72 dst_sel:DWORD dst_unused:UNUSED_PAD src0_sel:DWORD src1_sel:BYTE_2
    ds_add_rtn_u32 v82, v82, v3 offset:0
    v_lshlrev_b32_sdwa v83, 2, v72 dst_sel:DWORD dst_unused:UNUSED_PAD src0_sel:DWORD src1_sel:BYTE_3
    ds_add_rtn_u32 v83, v83, v3 offset:0
    s_waitcnt lgkmcnt(8)
    s_mov_b64 exec, s[54:55]
    ds_write_b32 v84, v62
    ds_write_b32 v85, v63
    ds_write_b32 v86, v64
    ds_write_b32 v87, v65
    s_waitcnt vmcnt(4)
    s_mov_b64 exec, s[58:59]
    v_lshlrev_b32_sdwa v84, 2, v78 dst_sel:DWORD dst_unused:UNUSED_PAD src0_sel:DWORD src1_sel:BYTE_0
    ds_add_rtn_u32 v84, v84, v3 offset:0
    v_lshlrev_b32_sdwa v85, 2, v78 dst_sel:DWORD dst_unused:UNUSED_PAD src0_sel:DWORD src1_sel:BYTE_1
    ds_add_rtn_u32 v85, v85, v3 offset:0
    v_lshlrev_b32_sdwa v86, 2, v78 dst_sel:DWORD dst_unused:UNUSED_PAD src0_sel:DWORD src1_sel:BYTE_2
    ds_add_rtn_u32 v86, v86, v3 offset:0
    v_lshlrev_b32_sdwa v87, 2, v78 dst_sel:DWORD dst_unused:UNUSED_PAD src0_sel:DWORD src1_sel:BYTE_3
    ds_add_rtn_u32 v87, v87, v3 offset:0
    s_waitcnt lgkmcnt(8)
    s_mov_b64 exec, s[56:57]
    ds_write_b32 v80, v68
    ds_write_b32 v81, v69
    ds_write_b32 v82, v70
    ds_write_b32 v83, v71
    s_waitcnt lgkmcnt(4)
    s_mov_b64 exec, s[58:59]
    ds_write_b32 v84, v74
    ds_write_b32 v85, v75
    ds_write_b32 v86, v76
    ds_write_b32 v87, v77
    s_branch L_taken
L_final1:
    s_mov_b64 exec, s[74:75]
    s_add_u32 m0, s76, 0
    s_nop 0
    buffer_load_dwordx4 v126, s[28:31], s73 offen offset:0 lds
    s_add_u32 m0, s76, 0
    s_nop 0
    buffer_load_dwordx4 v126, s[28:31], s73 offen offset:1024 lds
    s_add_u32 m0, s76, 0
    s_mov_b32 exec_hi, 0
    buffer_load_dwordx4 v126, s[28:31], s73 offen offset:2048 lds
    s_add_u32 m0, s76, 2560
    s_and_b32 exec_hi, s75, 0x1ff
    buffer_load_dword v107, s[36:39], s72 offen lds
    s_mov_b64 s[74:75], 0
    s_waitcnt vmcnt(10)
    s_mov_b64 exec, s[44:45]
    v_lshlrev_b32_sdwa v80, 2, v36 dst_sel:DWORD dst_unused:UNUSED_PAD src0_sel:DWORD src1_sel:BYTE_0
    ds_add_rtn_u32 v80, v80, v3 offset:0
    v_lshlrev_b32_sdwa v81, 2, v36 dst_sel:DWORD dst_unused:UNUSED_PAD src0_sel:DWORD src1_sel:BYTE_1
    ds_add_rtn_u32 v81, v81, v3 offset:0
    v_lshlrev_b32_sdwa v82, 2, v36 dst_sel:DWORD dst_unused:UNUSED_PAD src0_sel:DWORD src1_sel:BYTE_2
    ds_add_rtn_u32 v82, v82, v3 offset:0
    v_lshlrev_b32_sdwa v83, 2, v36 dst_sel:DWORD dst_unused:UNUSED_PAD src0_sel:DWORD src1_sel:BYTE_3
    ds_add_rtn_u32 v83, v83, v3 offset:0
    s_waitcnt vmcnt(8)
    s_mov_b64 exec, s[46:47]
    v_lshlrev_b32_sdwa v84, 2, v42 dst_sel:DWORD dst_unused:UNUSED_PAD src0_sel:DWORD src1_sel:BYTE_0
    ds_add_rtn_u32 v84, v84, v3 offset:0
    v_lshlrev_b32_sdwa v85, 2, v42 dst_sel:DWORD dst_unused:UNUSED_PAD src0_sel:DWORD src1_sel:BYTE_1
    ds_add_rtn_u32 v85, v85, v3 offset:0
    v_lshlrev_b32_sdwa v86, 2, v42 dst_sel:DWORD dst_unused:UNUSED_PAD src0_sel:DWORD src1_sel:BYTE_2
    ds_add_rtn_u32 v86, v86, v3 offset:0
    v_lshlrev_b32_sdwa v87, 2, v42 dst_sel:DWORD dst_unused:UNUSED_PAD src0_sel:DWORD src1_sel:BYTE_3
    ds_add_rtn_u32 v87, v87, v3 offset:0
    s_waitcnt lgkmcnt(4)
    s_mov_b64 exec, s[44:45]
    ds_write_b32 v80, v32
    ds_write_b32 v81, v33
    ds_write_b32 v82, v34
    ds_write_b32 v83, v35
    s_waitcnt vmcnt(6)
    s_mov_b64 exec, s[48:49]
    v_lshlrev_b32_sdwa v80, 2, v48 dst_sel:DWORD dst_unused:UNUSED_PAD src0_sel:DWORD src1_sel:BYTE_0
    ds_add_rtn_u32 v80, v80, v3 offset:0
    v_lshlrev_b32_sdwa v81, 2, v48 dst_sel:DWORD dst_unused:UNUSED_PAD src0_sel:DWORD src1_sel:BYTE_1
    ds_add_rtn_u32 v81, v81, v3 offset:0
    v_lshlrev_b32_sdwa v82, 2, v48 dst_sel:DWORD dst_unused:UNUSED_PAD src0_sel:DWORD src1_sel:BYTE_2
    ds_add_rtn_u32 v82, v82, v3 offset:0
    v_lshlrev_b32_sdwa v83, 2, v48 dst_sel:DWORD dst_unused:UNUSED_PAD src0_sel:DWORD src1_sel:BYTE_3
    ds_add_rtn_u32 v83, v83, v3 offset:0
    s_waitcnt lgkmcnt(8)
    s_mov_b64 exec, s[46:47]
    ds_write_b32 v84, v38
    ds_write_b32 v85, v39
    ds_write_b32 v86, v40
    ds_write_b32 v87, v41
    s_waitcnt vmcnt(4)
    s_mov_b64 exec, s[50:51]
    v_lshlrev_b32_sdwa v84, 2, v54 dst_sel:DWORD dst_unused:UNUSED_PAD src0_sel:DWORD src1_sel:BYTE_0
    ds_add_rtn_u32 v84, v84, v3 offset:0
    v_lshlrev_b32_sdwa v85, 2, v54 dst_sel:DWORD dst_unused:UNUSED_PAD src0_sel:DWORD src1_sel:BYTE_1
    ds_add_rtn_u32 v85, v85, v3 offset:0
    v_lshlrev_b32_sdwa v86, 2, v54 dst_sel:DWORD dst_unused:UNUSED_PAD src0_sel:DWORD src1_sel:BYTE_2
    ds_add_rtn_u32 v86, v86, v3 offset:0
    v_lshlrev_b32_sdwa v87, 2, v54 dst_sel:DWORD dst_unused:UNUSED_PAD src0_sel:DWORD src1_sel:BYTE_3
    ds_add_rtn_u32 v87, v87, v3 offset:0
    s_waitcnt lgkmcnt(8)
    s_mov_b64 exec, s[48:49]
    ds_write_b32 v80, v44
    ds_write_b32 v81, v45
    ds_write_b32 v82, v46
    ds_write_b32 v83, v47
    s_waitcnt lgkmcnt(4)
    s_mov_b64 exec, s[50:51]
    ds_write_b32 v84, v50
    ds_write_b32 v85, v51
    ds_write_b32 v86, v52
    ds_write_b32 v87, v53
    s_branch L_taken
L_idle:
    s_cmp_eq_u32 s60, 0
    s_cbranch_scc1 L_idle_late
    s_cmp_lt_u32 s89, 2
    s_cbranch_scc1 L_idle2
L_idle_late:
    s_mov_b64 exec, s[74:75]
    s_add_u32 m0, s76, 0
    s_nop 0
    buffer_load_dwordx4 v126, s[28:31], s73 offen offset:0 lds
    s_add_u32 m0, s76, 0
    s_nop 0
    buffer_load_dwordx4 v126, s[28:31], s73 offen offset:1024 lds
    s_add_u32 m0, s76, 0
    s_mov_b32 exec_hi, 0
    buffer_load_dwordx4 v126, s[28:31], s73 offen offset:2048 lds
    s_add_u32 m0, s76, 2560
    s_and_b32 exec_hi, s75, 0x1ff
    buffer_load_dword v107, s[36:39], s72 offen lds
    s_mov_b64 s[74:75], 0
    s_cmp_eq_u32 s60, 0
    s_cbranch_scc1 L_taken
L_idle2:
    s_add_u32 s89, s89, 1
    s_cmp_gt_u32 s89, 1048576
    s_cbranch_scc1 L_end
L_idle3:
    s_mov_b32 exec_lo, s60
    s_mov_b32 exec_hi, 0
    buffer_load_dword v104, v102, s[20:23], s64 offen sc1
    s_waitcnt vmcnt(0)
    s_branch L_top0
L_taken:
    s_mov_b64 exec, -1
    s_mov_b32 s83, 1
    s_mov_b32 s84, 1
    s_movk_i32 s44, 0xf0
    s_movk_i32 s45, 0x70
    s_lshl_b32 s46, s88, 12
    s_add_u32 s46, s46, 92288
    s_mul_i32 s49, s3, 20000
    v_lshlrev_b32 v16, 2, v1
    s_waitcnt lgkmcnt(0)
    s_barrier
    ds_read_b32 v17, v16 offset:0
    ds_read_b32 v18, v16 offset:256
    ds_read_b32 v19, v16 offset:512
    ds_read_b32 v20, v16 offset:768
    ds_read_b32 v12, v11 offset:0
    s_waitcnt lgkmcnt(1)
    v_cmp_gt_u32 vcc, v17, v108
    v_cmp_gt_u32 s[60:61], v18, v109
    v_cmp_gt_u32 s[62:63], v19, v110
    v_cmp_gt_u32 s[64:65], v20, v111
    s_or_b64 vcc, vcc, s[60:61]
    s_or_b64 vcc, vcc, s[62:63]
    s_or_b64 vcc, vcc, s[64:65]
    s_cbranch_scc0 L_G
    s_cmp_lg_u32 s79, 0
    s_cbranch_scc1 L_G
    v_lshlrev_b32 v16, 4, v1
    ds_read_b128 v[20:23], v16 offset:0
    s_waitcnt lgkmcnt(0)
    v_lshl_add_u32 v29, v1, 2, 0
    v_mul_u32_u24 v17, 384, v29
    v_add_u32 v17, 14976, v17
    v_subrev_u32 v29, 1, v29
    v_sub_u32 v20, v20, v17
    v_cmp_gt_u32 vcc, 200, v29
    v_add_u32 v20, 127, v20
    v_and_b32 v20, 0xffffff80, v20
    v_cndmask_b32 v20, v4, v20, vcc
    v_lshl_add_u32 v29, v1, 2, 1
    v_mul_u32_u24 v17, 384, v29
    v_add_u32 v17, 14976, v17
    v_subrev_u32 v29, 1, v29
    v_sub_u32 v21, v21, v17
    v_cmp_gt_u32 vcc, 200, v29
    v_add_u32 v21, 127, v21
    v_and_b32 v21, 0xffffff80, v21
    v_cndmask_b32 v21, v4, v21, vcc
    v_lshl_add_u32 v29, v1, 2, 2
    v_mul_u32_u24 v17, 384, v29
    v_add_u32 v17, 14976, v17
    v_subrev_u32 v29, 1, v29
    v_sub_u32 v22, v22, v17
    v_cmp_gt_u32 vcc, 200, v29
    v_add_u32 v22, 127, v22
    v_and_b32 v22, 0xffffff80, v22
    v_cndmask_b32 v22, v4, v22, vcc
    v_lshl_add_u32 v29, v1, 2, 3
    v_mul_u32_u24 v17, 384, v29
    v_add_u32 v17, 14976, v17
    v_subrev_u32 v29, 1, v29
    v_sub_u32 v23, v23, v17
    v_cmp_gt_u32 vcc, 200, v29
    v_add_u32 v23, 127, v23
    v_and_b32 v23, 0xffffff80, v23
    v_cndmask_b32 v23, v4, v23, vcc
    v_add_u32 v26, v20, v21
    v_add_u32 v27, v26, v22
    v_add_u32 v24, v27, v23
    v_mov_b32 v28, v24
    s_nop 1
    v_add_u32_dpp v28, v28, v28 row_shr:1 row_mask:0xf bank_mask:0xf
    s_nop 1
    v_add_u32_dpp v28, v28, v28 row_shr:2 row_mask:0xf bank_mask:0xf
    s_nop 1
    v_add_u32_dpp v28, v28, v28 row_shr:4 row_mask:0xf bank_mask:0xf
    s_nop 1
    v_add_u32_dpp v28, v28, v28 row_shr:8 row_mask:0xf bank_mask:0xf
    s_nop 1
    v_add_u32_dpp v28, v28, v28 row_bcast:15 row_mask:0xa bank_mask:0xf
    s_nop 1
    v_add_u32_dpp v28, v28, v28 row_bcast:31 row_mask:0xc bank_mask:0xf
    v_sub_u32 v24, v28, v24
    v_add_u32 v24, 15360, v24
    v_add_u32 v25, v24, v20
    v_add_u32 v26, v24, v26
    v_add_u32 v27, v24, v27
    v_readlane_b32 s58, v28, 63
    s_mov_b32 s59, 12288
    v_writelane_b32 v24, s59, 0
    s_cmp_gt_u32 s58, 76800
    s_cbranch_scc1 L_slow_init
    s_waitcnt vmcnt(0)
    s_barrier
    ds_write_b128 v16, v[24:27] offset:0
    v_lshlrev_b32 v20, 4, v0
    v_mov_b32 v248, 0
    v_mov_b32 v249, 0
    v_mov_b32 v250, 0
    v_mov_b32 v251, 0
    v_add_u32 v20, 4096, v20
    v_add_u32 v21, 65536, v20
    v_cmp_gt_u32 vcc, 392, v0
    ds_write_b128 v20, v[248:251] offset:0
    ds_write_b128 v20, v[248:251] offset:8192
    ds_write_b128 v20, v[248:251] offset:16384
    ds_write_b128 v20, v[248:251] offset:24576
    ds_write_b128 v20, v[248:251] offset:32768
    ds_write_b128 v20, v[248:251] offset:40960
    ds_write_b128 v20, v[248:251] offset:49152
    ds_write_b128 v20, v[248:251] offset:57344
    ds_write_b128 v21, v[248:251] offset:0
    ds_write_b128 v21, v[248:251] offset:8192
    s_mov_b64 exec, vcc
    ds_write_b128 v21, v[248:251] offset:16384
    s_mov_b64 exec, -1
    s_waitcnt lgkmcnt(0)
    s_barrier
    ds_read_b32 v17, v11 offset:0
    v_cmp_lt_u32 vcc, 24, v1
    s_mov_b32 s79, 1
    s_mov_b32 s60, -1
    s_mov_b32 s61, 0
    s_mov_b32 s62, 0
    s_lshl_b32 s64, s3, 2
    s_mov_b64 s[74:75], -1
    s_waitcnt lgkmcnt(0)
    v_cndmask_b32 v10, v17, v10, vcc
    s_barrier
    s_branch L_idle3
L_slow_init:
    s_mov_b32 s85, 0
    s_mov_b32 s86, 0
    s_mov_b32 s83, 0
    s_mov_b64 s[74:75], -1
L_slow:
    s_waitcnt vmcnt(0) lgkmcnt(0)
    s_barrier
    s_mov_b64 exec, s[74:75]
    s_add_u32 m0, s76, 0
    s_nop 0
    buffer_load_dwordx4 v126, s[28:31], s73 offen offset:0 lds
    s_add_u32 m0, s76, 0
    s_nop 0
    buffer_load_dwordx4 v126, s[28:31], s73 offen offset:1024 lds
    s_add_u32 m0, s76, 0
    s_mov_b32 exec_hi, 0
    buffer_load_dwordx4 v126, s[28:31], s73 offen offset:2048 lds
    s_add_u32 m0, s76, 2560
    s_and_b32 exec_hi, s75, 0x1ff
    buffer_load_dword v107, s[36:39], s72 offen lds
    s_mov_b64 s[74:75], 0
    s_mov_b64 exec, -1
    v_mul_u32_u24 v16, 384, v0
    v_add_u32 v16, 14976, v16
    v_mov_b32 v17, 12288
    v_cmp_eq_u32 vcc, 0, v0
    v_mov_b32 v18, 0
    v_lshlrev_b32 v19, 2, v0
    v_cndmask_b32 v16, v16, v17, vcc
    v_cmp_lt_u32 vcc, 200, v0
    s_nop 1
    v_cndmask_b32 v16, v16, v18, vcc
    v_cmp_gt_u32 vcc, 256, v0
    s_and_saveexec_b64 s[58:59], vcc
    ds_write_b32 v19, v16 offset:0
    s_mov_b64 exec, s[58:59]
    v_lshlrev_b32 v20, 4, v0
    v_mov_b32 v248, 0
    v_mov_b32 v249, 0
    v_mov_b32 v250, 0
    v_mov_b32 v251, 0
    v_add_u32 v20, 4096, v20
    v_add_u32 v21, 65536, v20
    v_cmp_gt_u32 vcc, 392, v0
    ds_write_b128 v20, v[248:251] offset:0
    ds_write_b128 v20, v[248:251] offset:8192
    ds_write_b128 v20, v[248:251] offset:16384
    ds_write_b128 v20, v[248:251] offset:24576
    ds_write_b128 v20, v[248:251] offset:32768
    ds_write_b128 v20, v[248:251] offset:40960
    ds_write_b128 v20, v[248:251] offset:49152
    ds_write_b128 v20, v[248:251] offset:57344
    ds_write_b128 v21, v[248:251] offset:0
    ds_write_b128 v21, v[248:251] offset:8192
    s_mov_b64 exec, vcc
    ds_write_b128 v21, v[248:251] offset:16384
    s_mov_b64 exec, -1
    s_waitcnt lgkmcnt(0)
    s_barrier
    s_cmp_lt_u32 s85, 256
    s_cbranch_scc1 L_slow_unit
    s_mov_b32 s83, 1
    s_branch L_slow_go
L_slow_unit:
    s_lshl_b32 s58, s85, 10
    s_lshl_b32 s59, s3, 2
    s_add_u32 s58, s58, s59
    buffer_load_dword v16, v4, s[20:23], s58 offen sc1
    s_waitcnt vmcnt(0)
    v_readfirstlane_b32 s60, v16
    s_and_b32 s59, s60, 0xfff
    s_mul_i32 s59, s59, 20
    s_bfe_u32 s60, s60, 0xc000c
    s_mul_i32 s60, s60, 20
    s_mul_i32 s61, s85, 53888
    s_add_u32 s61, s61, s59
    s_add_u32 s61, s61, s86
    s_sub_u32 s62, s60, s86
    s_min_u32 s62, s62, 480
    s_cmp_lg_u32 s88, 0
    s_cbranch_scc1 L_slow_adv
    v_mul_u32_u24 v16, 20, v1
    v_cmp_gt_u32 s[64:65], s62, v16
    s_mov_b64 exec, s[64:65]
    buffer_load_dwordx4 v[32:35], v16, s[24:27], s61 offen sc1
    buffer_load_dword v36, v16, s[24:27], s61 offen offset:16 sc1
    s_waitcnt vmcnt(0)
    s_mov_b64 exec, s[64:65]
    v_lshlrev_b32_sdwa v80, 2, v36 dst_sel:DWORD dst_unused:UNUSED_PAD src0_sel:DWORD src1_sel:BYTE_0
    ds_add_rtn_u32 v80, v80, v3 offset:0
    v_lshlrev_b32_sdwa v81, 2, v36 dst_sel:DWORD dst_unused:UNUSED_PAD src0_sel:DWORD src1_sel:BYTE_1
    ds_add_rtn_u32 v81, v81, v3 offset:0
    v_lshlrev_b32_sdwa v82, 2, v36 dst_sel:DWORD dst_unused:UNUSED_PAD src0_sel:DWORD src1_sel:BYTE_2
    ds_add_rtn_u32 v82, v82, v3 offset:0
    v_lshlrev_b32_sdwa v83, 2, v36 dst_sel:DWORD dst_unused:UNUSED_PAD src0_sel:DWORD src1_sel:BYTE_3
    ds_add_rtn_u32 v83, v83, v3 offset:0
    s_waitcnt lgkmcnt(0)
    s_mov_b64 exec, s[64:65]
    ds_write_b32 v80, v32
    ds_write_b32 v81, v33
    ds_write_b32 v82, v34
    ds_write_b32 v83, v35
    s_mov_b64 exec, -1
L_slow_adv:
    s_add_u32 s86, s86, 480
    s_cmp_lt_u32 s86, s60
    s_cbranch_scc1 L_slow_go
    s_add_u32 s85, s85, 1
    s_mov_b32 s86, 0
L_slow_go:
    s_waitcnt lgkmcnt(0)
    s_barrier
    ds_read_b32 v12, v11 offset:0
L_G:
    v_cmp_lt_u32 vcc, 24, v1
    v_add_u32 v17, 128, v10
    s_mov_b32 s48, 0
    s_waitcnt lgkmcnt(0)
    v_cndmask_b32 v12, v12, v17, vcc
    v_cmp_gt_u32 vcc, v12, v10
    v_sub_u32 v12, v12, v10
    v_add_u32 v12, 127, v12
    v_and_b32 v12, 0xffffff80, v12
    v_add_u32 v12, v12, v10
    s_and_b32 s50, vcc_lo, 33554431
    s_ff1_i32_b32 s51, s50
    s_bitset0_b32 s50, s51
    v_readlane_b32 s52, v10, s51
    v_readlane_b32 s53, v12, s51
    v_readlane_b32 s54, v13, s51
    s_mov_b32 s58, s54
    s_nop 0
    v_add_u32 v16, s52, v5
    ds_read_b32 v96, v16
    s_add_u32 s52, s52, 128
    s_cmp_lg_u32 s52, s53
    s_cbranch_scc1 L_pro0
    s_ff1_i32_b32 s51, s50
    s_bitset0_b32 s50, s51
    v_readlane_b32 s52, v10, s51
    v_readlane_b32 s53, v12, s51
    v_readlane_b32 s54, v13, s51
L_pro0:
    s_mov_b32 s59, s54
    s_nop 0
    v_add_u32 v17, s52, v5
    ds_read_b32 v97, v17
    s_add_u32 s52, s52, 128
    s_cmp_lg_u32 s52, s53
    s_cbranch_scc1 L_pro1
    s_ff1_i32_b32 s51, s50
    s_bitset0_b32 s50, s51
    v_readlane_b32 s52, v10, s51
    v_readlane_b32 s53, v12, s51
    v_readlane_b32 s54, v13, s51
L_pro1:
    s_mov_b32 s60, s54
    s_nop 0
    v_add_u32 v18, s52, v5
    ds_read_b32 v98, v18
    s_add_u32 s52, s52, 128
    s_cmp_lg_u32 s52, s53
    s_cbranch_scc1 L_pro2
    s_ff1_i32_b32 s51, s50
    s_bitset0_b32 s50, s51
    v_readlane_b32 s52, v10, s51
    v_readlane_b32 s53, v12, s51
    v_readlane_b32 s54, v13, s51
L_pro2:
    s_add_u32 m0, s46, 0
    s_waitcnt lgkmcnt(2)
    v_mad_u32_u16 v16, v96, 32, v6 op_sel:[1,0,0,0]
    buffer_load_dwordx4 v16, s[28:31], s58 offen  lds
    s_add_u32 m0, s46, 1024
    s_waitcnt lgkmcnt(1)
    v_mad_u32_u16 v17, v97, 32, v6 op_sel:[1,0,0,0]
    buffer_load_dwordx4 v17, s[28:31], s59 offen  lds
    s_mov_b32 s57, s60
    s_waitcnt lgkmcnt(0)
    s_movk_i32 s47, 2048
    s_cmp_eq_u32 s84, 0
    s_cbranch_scc1 L_gates_done
    s_mov_b32 s84, 0
    v_and_b32 v20, 15, v1
    v_lshrrev_b32 v21, 4, v1
    v_lshlrev_b32 v20, 1, v20
    v_lshl_add_u32 v22, v21, 6, v20
    v_lshl_add_u32 v20, v21, 7, v20
    v_lshlrev_b32 v21, 2, v21
    ds_read_u16 v208, v20 offset:1024
    ds_read_u16 v212, v20 offset:1536
    ds_read_u16 v209, v20 offset:1056
    ds_read_u16 v213, v20 offset:1568
    ds_read_u16 v210, v20 offset:1088
    ds_read_u16 v214, v20 offset:1600
    ds_read_u16 v211, v20 offset:1120
    ds_read_u16 v215, v20 offset:1632
    ds_read_u16 v216, v22 offset:2048
    ds_read_u16 v218, v22 offset:2304
    ds_read_u16 v217, v22 offset:2080
    ds_read_u16 v219, v22 offset:2336
    ds_read_b32 v220, v21 offset:2560
    s_waitcnt vmcnt(2)
    ds_read_u16 v202, v128 offset:2560
    ds_read_u16 v203, v128 offset:2592
    ds_read_u16 v204, v128 offset:2624
    ds_read_u16 v205, v128 offset:2656
    ds_read_u16 v206, v128 offset:2688
    ds_read_b64 v[192:193], v127 offset:0
    ds_read_b64 v[194:195], v127 offset:512
    ds_read_b64 v[196:197], v127 offset:1024
    ds_read_b64 v[198:199], v127 offset:1536
    ds_read_b64 v[200:201], v127 offset:2048
    s_waitcnt lgkmcnt(0)
    v_lshl_or_b32 v224, v209, 16, v208
    v_lshl_or_b32 v225, v211, 16, v210
    v_lshl_or_b32 v228, v213, 16, v212
    v_lshl_or_b32 v229, v215, 16, v214
    v_lshl_or_b32 v232, v217, 16, v216
    v_lshl_or_b32 v234, v219, 16, v218
    v_mov_b32 v226, v224
    v_mov_b32 v227, v225
    v_mov_b32 v230, v228
    v_mov_b32 v231, v229
    v_mov_b32 v233, 0
    v_mov_b32 v235, 0
    v_mov_b32 v237, 0
    v_mov_b32 v239, 0
    v_and_b32 v221, 0xffff0000, v220
    v_lshlrev_b32 v220, 16, v220
    v_lshlrev_b32 v22, 16, v202
    v_sub_f32 v20, v22, v220
    v_sub_f32 v21, v22, v221
    v_cvt_pk_bf16_f32 v22, v20, v21
    v_lshlrev_b32 v20, 16, v22
    v_and_b32 v21, 0xffff0000, v22
    v_mul_f32 v20, v20, v20
    v_mul_f32 v21, v21, v21
    v_cvt_pk_bf16_f32 v22, v20, v21
    v_lshlrev_b32 v20, 16, v22
    v_and_b32 v21, 0xffff0000, v22
    v_mul_f32 v20, 0xc1200000, v20
    v_mul_f32 v21, 0xc1200000, v21
    v_cvt_pk_bf16_f32 v22, v20, v21
    v_lshlrev_b32 v20, 16, v22
    v_and_b32 v21, 0xffff0000, v22
    v_mul_f32 v20, 0x3fb8aa3b, v20
    v_mul_f32 v21, 0x3fb8aa3b, v21
    v_exp_f32 v20, v20
    v_exp_f32 v21, v21
    s_nop 0
    v_cvt_pk_bf16_f32 v236, v20, v21
    s_nop 1
    v_mfma_f32_16x16x16_bf16 v[152:155], v[232:233], v[236:237], 0
    v_mfma_f32_16x16x16_bf16 v[172:175], v[234:235], v[236:237], 0
    v_lshlrev_b32 v22, 16, v203
    v_sub_f32 v20, v22, v220
    v_sub_f32 v21, v22, v221
    v_cvt_pk_bf16_f32 v22, v20, v21
    v_lshlrev_b32 v20, 16, v22
    v_and_b32 v21, 0xffff0000, v22
    v_mul_f32 v20, v20, v20
    v_mul_f32 v21, v21, v21
    v_cvt_pk_bf16_f32 v22, v20, v21
    v_lshlrev_b32 v20, 16, v22
    v_and_b32 v21, 0xffff0000, v22
    v_mul_f32 v20, 0xc1200000, v20
    v_mul_f32 v21, 0xc1200000, v21
    v_cvt_pk_bf16_f32 v22, v20, v21
    v_lshlrev_b32 v20, 16, v22
    v_and_b32 v21, 0xffff0000, v22
    v_mul_f32 v20, 0x3fb8aa3b, v20
    v_mul_f32 v21, 0x3fb8aa3b, v21
    v_exp_f32 v20, v20
    v_exp_f32 v21, v21
    s_nop 0
    v_cvt_pk_bf16_f32 v238, v20, v21
    s_nop 1
    v_mfma_f32_16x16x16_bf16 v[156:159], v[232:233], v[238:239], 0
    v_mfma_f32_16x16x16_bf16 v[176:179], v[234:235], v[238:239], 0
    v_lshlrev_b32 v22, 16, v204
    v_sub_f32 v20, v22, v220
    v_sub_f32 v21, v22, v221
    v_cvt_pk_bf16_f32 v22, v20, v21
    v_lshlrev_b32 v20, 16, v22
    v_and_b32 v21, 0xffff0000, v22
    v_mul_f32 v20, v20, v20
    v_mul_f32 v21, v21, v21
    v_cvt_pk_bf16_f32 v22, v20, v21
    v_lshlrev_b32 v20, 16, v22
    v_and_b32 v21, 0xffff0000, v22
    v_mul_f32 v20, 0xc1200000, v20
    v_mul_f32 v21, 0xc1200000, v21
    v_cvt_pk_bf16_f32 v22, v20, v21
    v_lshlrev_b32 v20, 16, v22
    v_and_b32 v21, 0xffff0000, v22
    v_mul_f32 v20, 0x3fb8aa3b, v20
    v_mul_f32 v21, 0x3fb8aa3b, v21
    v_exp_f32 v20, v20
    v_exp_f32 v21, v21
    s_nop 0
    v_cvt_pk_bf16_f32 v236, v20, v21
    s_nop 1
    v_mfma_f32_16x16x16_bf16 v[160:163], v[232:233], v[236:237], 0
    v_mfma_f32_16x16x16_bf16 v[180:183], v[234:235], v[236:237], 0
    v_lshlrev_b32 v22, 16, v205
    v_sub_f32 v20, v22, v220
    v_sub_f32 v21, v22, v221
    v_cvt_pk_bf16_f32 v22, v20, v21
    v_lshlrev_b32 v20, 16, v22
    v_and_b32 v21, 0xffff0000, v22
    v_mul_f32 v20, v20, v20
    v_mul_f32 v21, v21, v21
    v_cvt_pk_bf16_f32 v22, v20, v21
    v_lshlrev_b32 v20, 16, v22
    v_and_b32 v21, 0xffff0000, v22
    v_mul_f32 v20, 0xc1200000, v20
    v_mul_f32 v21, 0xc1200000, v21
    v_cvt_pk_bf16_f32 v22, v20, v21
    v_lshlrev_b32 v20, 16, v22
    v_and_b32 v21, 0xffff0000, v22
    v_mul_f32 v20, 0x3fb8aa3b, v20
    v_mul_f32 v21, 0x3fb8aa3b, v21
    v_exp_f32 v20, v20
    v_exp_f32 v21, v21
    s_nop 0
    v_cvt_pk_bf16_f32 v238, v20, v21
    s_nop 1
    v_mfma_f32_16x16x16_bf16 v[164:167], v[232:233], v[238:239], 0
    v_mfma_f32_16x16x16_bf16 v[184:187], v[234:235], v[238:239], 0
    v_lshlrev_b32 v22, 16, v206
    v_sub_f32 v20, v22, v220
    v_sub_f32 v21, v22, v221
    v_cvt_pk_bf16_f32 v22, v20, v21
    v_lshlrev_b32 v20, 16, v22
    v_and_b32 v21, 0xffff0000, v22
    v_mul_f32 v20, v20, v20
    v_mul_f32 v21, v21, v21
    v_cvt_pk_bf16_f32 v22, v20, v21
    v_lshlrev_b32 v20, 16, v22
    v_and_b32 v21, 0xffff0000, v22
    v_mul_f32 v20, 0xc1200000, v20
    v_mul_f32 v21, 0xc1200000, v21
    v_cvt_pk_bf16_f32 v22, v20, v21
    v_lshlrev_b32 v20, 16, v22
    v_and_b32 v21, 0xffff0000, v22
    v_mul_f32 v20, 0x3fb8aa3b, v20
    v_mul_f32 v21, 0x3fb8aa3b, v21
    v_exp_f32 v20, v20
    v_exp_f32 v21, v21
    s_nop 0
    v_cvt_pk_bf16_f32 v236, v20, v21
    s_nop 1
    v_mfma_f32_16x16x16_bf16 v[168:171], v[232:233], v[236:237], 0
    v_mfma_f32_16x16x16_bf16 v[188:191], v[234:235], v[236:237], 0
L_gates_done:
L_main:
    s_cmp_lt_u32 s88, 4
    s_cbranch_scc1 L_pr0
    s_setprio 1
L_pr0:
    v_readlane_b32 s55, v10, 0
    v_readlane_b32 s56, v12, 0
    s_cmp_eq_u32 s55, s56
    s_cbranch_scc1 L_bin0_done
L_bin0:
    s_add_u32 m0, s46, s47
    v_mad_u32_u16 v16, v98, 32, v6 op_sel:[1,0,0,0]
    v_and_b32 v18, 0xbff8, v96
    v_lshlrev_b32 v20, 4, v96
    buffer_load_dwordx4 v16, s[28:31], s57 offen  lds
    v_lshrrev_b32 v21, 7, v96
    v_cvt_f32_f16 v18, v18
    v_bfi_b32 v20, s45, v20, v21
    v_add_u32 v17, s52, v5
    v_and_or_b32 v20, v20, s44, v7
    v_mov_b32 v96, v97
    v_mov_b32 v97, v98
    ds_write_b16_d16_hi v20, v18
    ds_read_b128 v[244:247], v8
    ds_write_b16 v20, v4
    ds_read_b32 v98, v17
    v_add_u32 v19, s48, v9
    s_mov_b32 s57, s54
    s_add_u32 s52, s52, 128
    s_cmp_eq_u32 s52, s53
    s_cbranch_scc1 L_nb0
L_nb0_back:
    s_waitcnt vmcnt(2)
    ds_read_b64_tr_b16 v[240:241], v19
    ds_read_b64_tr_b16 v[242:243], v19 offset:256
    s_add_u32 s47, s47, 1024
    s_and_b32 s47, s47, 4095
    s_add_u32 s48, s48, 1024
    s_and_b32 s48, s48, 4095
    s_add_u32 s55, s55, 128
    s_cmp_lg_u32 s55, s56
    s_waitcnt lgkmcnt(0)
    v_mfma_f32_16x16x32_bf16 v[132:135], v[240:243], v[244:247], v[132:135]
    s_cbranch_scc1 L_bin0
L_bin0_done:
    s_cmp_lt_u32 s88, 4
    s_cbranch_scc1 L_pr1
    s_setprio 0
L_pr1:
    v_readlane_b32 s55, v10, 1
    v_readlane_b32 s56, v12, 1
    s_cmp_eq_u32 s55, s56
    s_cbranch_scc1 L_bin1_done
L_bin1:
    s_add_u32 m0, s46, s47
    v_mad_u32_u16 v16, v98, 32, v6 op_sel:[1,0,0,0]
    v_and_b32 v18, 0xbff8, v96
    v_lshlrev_b32 v20, 4, v96
    buffer_load_dwordx4 v16, s[28:31], s57 offen  lds
    v_lshrrev_b32 v21, 7, v96
    v_cvt_f32_f16 v18, v18
    v_bfi_b32 v20, s45, v20, v21
    v_add_u32 v17, s52, v5
    v_and_or_b32 v20, v20, s44, v7
    v_mov_b32 v96, v97
    v_mov_b32 v97, v98
    ds_write_b16_d16_hi v20, v18
    ds_read_b128 v[244:247], v8
    ds_write_b16 v20, v4
    ds_read_b32 v98, v17
    v_add_u32 v19, s48, v9
    s_mov_b32 s57, s54
    s_add_u32 s52, s52, 128
    s_cmp_eq_u32 s52, s53
    s_cbranch_scc1 L_nb1
L_nb1_back:
    s_waitcnt vmcnt(2)
    ds_read_b64_tr_b16 v[240:241], v19
    ds_read_b64_tr_b16 v[242:243], v19 offset:256
    s_add_u32 s47, s47, 1024
    s_and_b32 s47, s47, 4095
    s_add_u32 s48, s48, 1024
    s_and_b32 s48, s48, 4095
    s_add_u32 s55, s55, 128
    s_cmp_lg_u32 s55, s56
    s_waitcnt lgkmcnt(0)
    v_mfma_f32_16x16x32_bf16 v[136:139], v[240:243], v[244:247], v[136:139]
    s_cbranch_scc1 L_bin1
L_bin1_done:
    s_cmp_lt_u32 s88, 4
    s_cbranch_scc1 L_pr2
    s_setprio 1
L_pr2:
    v_readlane_b32 s55, v10, 2
    v_readlane_b32 s56, v12, 2
    s_cmp_eq_u32 s55, s56
    s_cbranch_scc1 L_bin2_done
L_bin2:
    s_add_u32 m0, s46, s47
    v_mad_u32_u16 v16, v98, 32, v6 op_sel:[1,0,0,0]
    v_and_b32 v18, 0xbff8, v96
    v_lshlrev_b32 v20, 4, v96
    buffer_load_dwordx4 v16, s[28:31], s57 offen  lds
    v_lshrrev_b32 v21, 7, v96
    v_cvt_f32_f16 v18, v18
    v_bfi_b32 v20, s45, v20, v21
    v_add_u32 v17, s52, v5
    v_and_or_b32 v20, v20, s44, v7
    v_mov_b32 v96, v97
    v_mov_b32 v97, v98
    ds_write_b16_d16_hi v20, v18
    ds_read_b128 v[244:247], v8
    ds_write_b16 v20, v4
    ds_read_b32 v98, v17
    v_add_u32 v19, s48, v9
    s_mov_b32 s57, s54
    s_add_u32 s52, s52, 128
    s_cmp_eq_u32 s52, s53
    s_cbranch_scc1 L_nb2
L_nb2_back:
    s_waitcnt vmcnt(2)
    ds_read_b64_tr_b16 v[240:241], v19
    ds_read_b64_tr_b16 v[242:243], v19 offset:256
    s_add_u32 s47, s47, 1024
    s_and_b32 s47, s47, 4095
    s_add_u32 s48, s48, 1024
    s_and_b32 s48, s48, 4095
    s_add_u32 s55, s55, 128
    s_cmp_lg_u32 s55, s56
    s_waitcnt lgkmcnt(0)
    v_mfma_f32_16x16x32_bf16 v[140:143], v[240:243], v[244:247], v[140:143]
    s_cbranch_scc1 L_bin2
L_bin2_done:
    s_cmp_lt_u32 s88, 4
    s_cbranch_scc1 L_pr3
    s_setprio 0
L_pr3:
    v_readlane_b32 s55, v10, 3
    v_readlane_b32 s56, v12, 3
    s_cmp_eq_u32 s55, s56
    s_cbranch_scc1 L_bin3_done
L_bin3:
    s_add_u32 m0, s46, s47
    v_mad_u32_u16 v16, v98, 32, v6 op_sel:[1,0,0,0]
    v_and_b32 v18, 0xbff8, v96
    v_lshlrev_b32 v20, 4, v96
    buffer_load_dwordx4 v16, s[28:31], s57 offen  lds
    v_lshrrev_b32 v21, 7, v96
    v_cvt_f32_f16 v18, v18
    v_bfi_b32 v20, s45, v20, v21
    v_add_u32 v17, s52, v5
    v_and_or_b32 v20, v20, s44, v7
    v_mov_b32 v96, v97
    v_mov_b32 v97, v98
    ds_write_b16_d16_hi v20, v18
    ds_read_b128 v[244:247], v8
    ds_write_b16 v20, v4
    ds_read_b32 v98, v17
    v_add_u32 v19, s48, v9
    s_mov_b32 s57, s54
    s_add_u32 s52, s52, 128
    s_cmp_eq_u32 s52, s53
    s_cbranch_scc1 L_nb3
L_nb3_back:
    s_waitcnt vmcnt(2)
    ds_read_b64_tr_b16 v[240:241], v19
    ds_read_b64_tr_b16 v[242:243], v19 offset:256
    s_add_u32 s47, s47, 1024
    s_and_b32 s47, s47, 4095
    s_add_u32 s48, s48, 1024
    s_and_b32 s48, s48, 4095
    s_add_u32 s55, s55, 128
    s_cmp_lg_u32 s55, s56
    s_waitcnt lgkmcnt(0)
    v_mfma_f32_16x16x32_bf16 v[144:147], v[240:243], v[244:247], v[144:147]
    s_cbranch_scc1 L_bin3
L_bin3_done:
    s_cmp_lt_u32 s88, 4
    s_cbranch_scc1 L_pr4
    s_setprio 1
L_pr4:
    v_readlane_b32 s55, v10, 4
    v_readlane_b32 s56, v12, 4
    s_cmp_eq_u32 s55, s56
    s_cbranch_scc1 L_bin4_done
L_bin4:
    s_add_u32 m0, s46, s47
    v_mad_u32_u16 v16, v98, 32, v6 op_sel:[1,0,0,0]
    v_and_b32 v18, 0xbff8, v96
    v_lshlrev_b32 v20, 4, v96
    buffer_load_dwordx4 v16, s[28:31], s57 offen  lds
    v_lshrrev_b32 v21, 7, v96
    v_cvt_f32_f16 v18, v18
    v_bfi_b32 v20, s45, v20, v21
    v_add_u32 v17, s52, v5
    v_and_or_b32 v20, v20, s44, v7
    v_mov_b32 v96, v97
    v_mov_b32 v97, v98
    ds_write_b16_d16_hi v20, v18
    ds_read_b128 v[244:247], v8
    ds_write_b16 v20, v4
    ds_read_b32 v98, v17
    v_add_u32 v19, s48, v9
    s_mov_b32 s57, s54
    s_add_u32 s52, s52, 128
    s_cmp_eq_u32 s52, s53
    s_cbranch_scc1 L_nb4
L_nb4_back:
    s_waitcnt vmcnt(2)
    ds_read_b64_tr_b16 v[240:241], v19
    ds_read_b64_tr_b16 v[242:243], v19 offset:256
    s_add_u32 s47, s47, 1024
    s_and_b32 s47, s47, 4095
    s_add_u32 s48, s48, 1024
    s_and_b32 s48, s48, 4095
    s_add_u32 s55, s55, 128
    s_cmp_lg_u32 s55, s56
    s_waitcnt lgkmcnt(0)
    v_mfma_f32_16x16x32_bf16 v[148:151], v[240:243], v[244:247], v[148:151]
    s_cbranch_scc1 L_bin4
L_bin4_done:
    s_cmp_lt_u32 s88, 4
    s_cbranch_scc1 L_pr5
    s_setprio 0
L_pr5:
    v_readlane_b32 s55, v10, 5
    v_readlane_b32 s56, v12, 5
    s_cmp_eq_u32 s55, s56
    s_cbranch_scc1 L_bin5_done
L_bin5:
    s_add_u32 m0, s46, s47
    v_mad_u32_u16 v16, v98, 32, v6 op_sel:[1,0,0,0]
    v_and_b32 v18, 0xbff8, v96
    v_lshlrev_b32 v20, 4, v96
    buffer_load_dwordx4 v16, s[28:31], s57 offen  lds
    v_lshrrev_b32 v21, 7, v96
    v_cvt_f32_f16 v18, v18
    v_bfi_b32 v20, s45, v20, v21
    v_add_u32 v17, s52, v5
    v_and_or_b32 v20, v20, s44, v7
    v_mov_b32 v96, v97
    v_mov_b32 v97, v98
    ds_write_b16_d16_hi v20, v18
    ds_read_b128 v[244:247], v8
    ds_write_b16 v20, v4
    ds_read_b32 v98, v17
    v_add_u32 v19, s48, v9
    s_mov_b32 s57, s54
    s_add_u32 s52, s52, 128
    s_cmp_eq_u32 s52, s53
    s_cbranch_scc1 L_nb5
L_nb5_back:
    s_waitcnt vmcnt(2)
    ds_read_b64_tr_b16 v[240:241], v19
    ds_read_b64_tr_b16 v[242:243], v19 offset:256
    s_add_u32 s47, s47, 1024
    s_and_b32 s47, s47, 4095
    s_add_u32 s48, s48, 1024
    s_and_b32 s48, s48, 4095
    s_add_u32 s55, s55, 128
    s_cmp_lg_u32 s55, s56
    s_waitcnt lgkmcnt(0)
    v_mfma_f32_16x16x32_bf16 v[132:135], v[240:243], v[244:247], v[132:135]
    s_cbranch_scc1 L_bin5
L_bin5_done:
    s_cmp_lt_u32 s88, 4
    s_cbranch_scc1 L_pr6
    s_setprio 1
L_pr6:
    v_readlane_b32 s55, v10, 6
    v_readlane_b32 s56, v12, 6
    s_cmp_eq_u32 s55, s56
    s_cbranch_scc1 L_bin6_done
L_bin6:
    s_add_u32 m0, s46, s47
    v_mad_u32_u16 v16, v98, 32, v6 op_sel:[1,0,0,0]
    v_and_b32 v18, 0xbff8, v96
    v_lshlrev_b32 v20, 4, v96
    buffer_load_dwordx4 v16, s[28:31], s57 offen  lds
    v_lshrrev_b32 v21, 7, v96
    v_cvt_f32_f16 v18, v18
    v_bfi_b32 v20, s45, v20, v21
    v_add_u32 v17, s52, v5
    v_and_or_b32 v20, v20, s44, v7
    v_mov_b32 v96, v97
    v_mov_b32 v97, v98
    ds_write_b16_d16_hi v20, v18
    ds_read_b128 v[244:247], v8
    ds_write_b16 v20, v4
    ds_read_b32 v98, v17
    v_add_u32 v19, s48, v9
    s_mov_b32 s57, s54
    s_add_u32 s52, s52, 128
    s_cmp_eq_u32 s52, s53
    s_cbranch_scc1 L_nb6
L_nb6_back:
    s_waitcnt vmcnt(2)
    ds_read_b64_tr_b16 v[240:241], v19
    ds_read_b64_tr_b16 v[242:243], v19 offset:256
    s_add_u32 s47, s47, 1024
    s_and_b32 s47, s47, 4095
    s_add_u32 s48, s48, 1024
    s_and_b32 s48, s48, 4095
    s_add_u32 s55, s55, 128
    s_cmp_lg_u32 s55, s56
    s_waitcnt lgkmcnt(0)
    v_mfma_f32_16x16x32_bf16 v[136:139], v[240:243], v[244:247], v[136:139]
    s_cbranch_scc1 L_bin6
L_bin6_done:
    s_cmp_lt_u32 s88, 4
    s_cbranch_scc1 L_pr7
    s_setprio 0
L_pr7:
    v_readlane_b32 s55, v10, 7
    v_readlane_b32 s56, v12, 7
    s_cmp_eq_u32 s55, s56
    s_cbranch_scc1 L_bin7_done
L_bin7:
    s_add_u32 m0, s46, s47
    v_mad_u32_u16 v16, v98, 32, v6 op_sel:[1,0,0,0]
    v_and_b32 v18, 0xbff8, v96
    v_lshlrev_b32 v20, 4, v96
    buffer_load_dwordx4 v16, s[28:31], s57 offen  lds
    v_lshrrev_b32 v21, 7, v96
    v_cvt_f32_f16 v18, v18
    v_bfi_b32 v20, s45, v20, v21
    v_add_u32 v17, s52, v5
    v_and_or_b32 v20, v20, s44, v7
    v_mov_b32 v96, v97
    v_mov_b32 v97, v98
    ds_write_b16_d16_hi v20, v18
    ds_read_b128 v[244:247], v8
    ds_write_b16 v20, v4
    ds_read_b32 v98, v17
    v_add_u32 v19, s48, v9
    s_mov_b32 s57, s54
    s_add_u32 s52, s52, 128
    s_cmp_eq_u32 s52, s53
    s_cbranch_scc1 L_nb7
L_nb7_back:
    s_waitcnt vmcnt(2)
    ds_read_b64_tr_b16 v[240:241], v19
    ds_read_b64_tr_b16 v[242:243], v19 offset:256
    s_add_u32 s47, s47, 1024
    s_and_b32 s47, s47, 4095
    s_add_u32 s48, s48, 1024
    s_and_b32 s48, s48, 4095
    s_add_u32 s55, s55, 128
    s_cmp_lg_u32 s55, s56
    s_waitcnt lgkmcnt(0)
    v_mfma_f32_16x16x32_bf16 v[140:143], v[240:243], v[244:247], v[140:143]
    s_cbranch_scc1 L_bin7
L_bin7_done:
    s_cmp_lt_u32 s88, 4
    s_cbranch_scc1 L_pr8
    s_setprio 1
L_pr8:
    v_readlane_b32 s55, v10, 8
    v_readlane_b32 s56, v12, 8
    s_cmp_eq_u32 s55, s56
    s_cbranch_scc1 L_bin8_done
L_bin8:
    s_add_u32 m0, s46, s47
    v_mad_u32_u16 v16, v98, 32, v6 op_sel:[1,0,0,0]
    v_and_b32 v18, 0xbff8, v96
    v_lshlrev_b32 v20, 4, v96
    buffer_load_dwordx4 v16, s[28:31], s57 offen  lds
    v_lshrrev_b32 v21, 7, v96
    v_cvt_f32_f16 v18, v18
    v_bfi_b32 v20, s45, v20, v21
    v_add_u32 v17, s52, v5
    v_and_or_b32 v20, v20, s44, v7
    v_mov_b32 v96, v97
    v_mov_b32 v97, v98
    ds_write_b16_d16_hi v20, v18
    ds_read_b128 v[244:247], v8
    ds_write_b16 v20, v4
    ds_read_b32 v98, v17
    v_add_u32 v19, s48, v9
    s_mov_b32 s57, s54
    s_add_u32 s52, s52, 128
    s_cmp_eq_u32 s52, s53
    s_cbranch_scc1 L_nb8
L_nb8_back:
    s_waitcnt vmcnt(2)
    ds_read_b64_tr_b16 v[240:241], v19
    ds_read_b64_tr_b16 v[242:243], v19 offset:256
    s_add_u32 s47, s47, 1024
    s_and_b32 s47, s47, 4095
    s_add_u32 s48, s48, 1024
    s_and_b32 s48, s48, 4095
    s_add_u32 s55, s55, 128
    s_cmp_lg_u32 s55, s56
    s_waitcnt lgkmcnt(0)
    v_mfma_f32_16x16x32_bf16 v[144:147], v[240:243], v[244:247], v[144:147]
    s_cbranch_scc1 L_bin8
L_bin8_done:
    s_cmp_lt_u32 s88, 4
    s_cbranch_scc1 L_pr9
    s_setprio 0
L_pr9:
    v_readlane_b32 s55, v10, 9
    v_readlane_b32 s56, v12, 9
    s_cmp_eq_u32 s55, s56
    s_cbranch_scc1 L_bin9_done
L_bin9:
    s_add_u32 m0, s46, s47
    v_mad_u32_u16 v16, v98, 32, v6 op_sel:[1,0,0,0]
    v_and_b32 v18, 0xbff8, v96
    v_lshlrev_b32 v20, 4, v96
    buffer_load_dwordx4 v16, s[28:31], s57 offen  lds
    v_lshrrev_b32 v21, 7, v96
    v_cvt_f32_f16 v18, v18
    v_bfi_b32 v20, s45, v20, v21
    v_add_u32 v17, s52, v5
    v_and_or_b32 v20, v20, s44, v7
    v_mov_b32 v96, v97
    v_mov_b32 v97, v98
    ds_write_b16_d16_hi v20, v18
    ds_read_b128 v[244:247], v8
    ds_write_b16 v20, v4
    ds_read_b32 v98, v17
    v_add_u32 v19, s48, v9
    s_mov_b32 s57, s54
    s_add_u32 s52, s52, 128
    s_cmp_eq_u32 s52, s53
    s_cbranch_scc1 L_nb9
L_nb9_back:
    s_waitcnt vmcnt(2)
    ds_read_b64_tr_b16 v[240:241], v19
    ds_read_b64_tr_b16 v[242:243], v19 offset:256
    s_add_u32 s47, s47, 1024
    s_and_b32 s47, s47, 4095
    s_add_u32 s48, s48, 1024
    s_and_b32 s48, s48, 4095
    s_add_u32 s55, s55, 128
    s_cmp_lg_u32 s55, s56
    s_waitcnt lgkmcnt(0)
    v_mfma_f32_16x16x32_bf16 v[148:151], v[240:243], v[244:247], v[148:151]
    s_cbranch_scc1 L_bin9
L_bin9_done:
    s_cmp_lt_u32 s88, 4
    s_cbranch_scc1 L_pr10
    s_setprio 1
L_pr10:
    v_readlane_b32 s55, v10, 10
    v_readlane_b32 s56, v12, 10
    s_cmp_eq_u32 s55, s56
    s_cbranch_scc1 L_bin10_done
L_bin10:
    s_add_u32 m0, s46, s47
    v_mad_u32_u16 v16, v98, 32, v6 op_sel:[1,0,0,0]
    v_and_b32 v18, 0xbff8, v96
    v_lshlrev_b32 v20, 4, v96
    buffer_load_dwordx4 v16, s[28:31], s57 offen  lds
    v_lshrrev_b32 v21, 7, v96
    v_cvt_f32_f16 v18, v18
    v_bfi_b32 v20, s45, v20, v21
    v_add_u32 v17, s52, v5
    v_and_or_b32 v20, v20, s44, v7
    v_mov_b32 v96, v97
    v_mov_b32 v97, v98
    ds_write_b16_d16_hi v20, v18
    ds_read_b128 v[244:247], v8
    ds_write_b16 v20, v4
    ds_read_b32 v98, v17
    v_add_u32 v19, s48, v9
    s_mov_b32 s57, s54
    s_add_u32 s52, s52, 128
    s_cmp_eq_u32 s52, s53
    s_cbranch_scc1 L_nb10
L_nb10_back:
    s_waitcnt vmcnt(2)
    ds_read_b64_tr_b16 v[240:241], v19
    ds_read_b64_tr_b16 v[242:243], v19 offset:256
    s_add_u32 s47, s47, 1024
    s_and_b32 s47, s47, 4095
    s_add_u32 s48, s48, 1024
    s_and_b32 s48, s48, 4095
    s_add_u32 s55, s55, 128
    s_cmp_lg_u32 s55, s56
    s_waitcnt lgkmcnt(0)
    v_mfma_f32_16x16x32_bf16 v[132:135], v[240:243], v[244:247], v[132:135]
    s_cbranch_scc1 L_bin10
L_bin10_done:
    s_cmp_lt_u32 s88, 4
    s_cbranch_scc1 L_pr11
    s_setprio 0
L_pr11:
    v_readlane_b32 s55, v10, 11
    v_readlane_b32 s56, v12, 11
    s_cmp_eq_u32 s55, s56
    s_cbranch_scc1 L_bin11_done
L_bin11:
    s_add_u32 m0, s46, s47
    v_mad_u32_u16 v16, v98, 32, v6 op_sel:[1,0,0,0]
    v_and_b32 v18, 0xbff8, v96
    v_lshlrev_b32 v20, 4, v96
    buffer_load_dwordx4 v16, s[28:31], s57 offen  lds
    v_lshrrev_b32 v21, 7, v96
    v_cvt_f32_f16 v18, v18
    v_bfi_b32 v20, s45, v20, v21
    v_add_u32 v17, s52, v5
    v_and_or_b32 v20, v20, s44, v7
    v_mov_b32 v96, v97
    v_mov_b32 v97, v98
    ds_write_b16_d16_hi v20, v18
    ds_read_b128 v[244:247], v8
    ds_write_b16 v20, v4
    ds_read_b32 v98, v17
    v_add_u32 v19, s48, v9
    s_mov_b32 s57, s54
    s_add_u32 s52, s52, 128
    s_cmp_eq_u32 s52, s53
    s_cbranch_scc1 L_nb11
L_nb11_back:
    s_waitcnt vmcnt(2)
    ds_read_b64_tr_b16 v[240:241], v19
    ds_read_b64_tr_b16 v[242:243], v19 offset:256
    s_add_u32 s47, s47, 1024
    s_and_b32 s47, s47, 4095
    s_add_u32 s48, s48, 1024
    s_and_b32 s48, s48, 4095
    s_add_u32 s55, s55, 128
    s_cmp_lg_u32 s55, s56
    s_waitcnt lgkmcnt(0)
    v_mfma_f32_16x16x32_bf16 v[136:139], v[240:243], v[244:247], v[136:139]
    s_cbranch_scc1 L_bin11
L_bin11_done:
    s_cmp_lt_u32 s88, 4
    s_cbranch_scc1 L_pr12
    s_setprio 1
L_pr12:
    v_readlane_b32 s55, v10, 12
    v_readlane_b32 s56, v12, 12
    s_cmp_eq_u32 s55, s56
    s_cbranch_scc1 L_bin12_done
L_bin12:
    s_add_u32 m0, s46, s47
    v_mad_u32_u16 v16, v98, 32, v6 op_sel:[1,0,0,0]
    v_and_b32 v18, 0xbff8, v96
    v_lshlrev_b32 v20, 4, v96
    buffer_load_dwordx4 v16, s[28:31], s57 offen  lds
    v_lshrrev_b32 v21, 7, v96
    v_cvt_f32_f16 v18, v18
    v_bfi_b32 v20, s45, v20, v21
    v_add_u32 v17, s52, v5
    v_and_or_b32 v20, v20, s44, v7
    v_mov_b32 v96, v97
    v_mov_b32 v97, v98
    ds_write_b16_d16_hi v20, v18
    ds_read_b128 v[244:247], v8
    ds_write_b16 v20, v4
    ds_read_b32 v98, v17
    v_add_u32 v19, s48, v9
    s_mov_b32 s57, s54
    s_add_u32 s52, s52, 128
    s_cmp_eq_u32 s52, s53
    s_cbranch_scc1 L_nb12
L_nb12_back:
    s_waitcnt vmcnt(2)
    ds_read_b64_tr_b16 v[240:241], v19
    ds_read_b64_tr_b16 v[242:243], v19 offset:256
    s_add_u32 s47, s47, 1024
    s_and_b32 s47, s47, 4095
    s_add_u32 s48, s48, 1024
    s_and_b32 s48, s48, 4095
    s_add_u32 s55, s55, 128
    s_cmp_lg_u32 s55, s56
    s_waitcnt lgkmcnt(0)
    v_mfma_f32_16x16x32_bf16 v[140:143], v[240:243], v[244:247], v[140:143]
    s_cbranch_scc1 L_bin12
L_bin12_done:
    s_cmp_lt_u32 s88, 4
    s_cbranch_scc1 L_pr13
    s_setprio 0
L_pr13:
    v_readlane_b32 s55, v10, 13
    v_readlane_b32 s56, v12, 13
    s_cmp_eq_u32 s55, s56
    s_cbranch_scc1 L_bin13_done
L_bin13:
    s_add_u32 m0, s46, s47
    v_mad_u32_u16 v16, v98, 32, v6 op_sel:[1,0,0,0]
    v_and_b32 v18, 0xbff8, v96
    v_lshlrev_b32 v20, 4, v96
    buffer_load_dwordx4 v16, s[28:31], s57 offen  lds
    v_lshrrev_b32 v21, 7, v96
    v_cvt_f32_f16 v18, v18
    v_bfi_b32 v20, s45, v20, v21
    v_add_u32 v17, s52, v5
    v_and_or_b32 v20, v20, s44, v7
    v_mov_b32 v96, v97
    v_mov_b32 v97, v98
    ds_write_b16_d16_hi v20, v18
    ds_read_b128 v[244:247], v8
    ds_write_b16 v20, v4
    ds_read_b32 v98, v17
    v_add_u32 v19, s48, v9
    s_mov_b32 s57, s54
    s_add_u32 s52, s52, 128
    s_cmp_eq_u32 s52, s53
    s_cbranch_scc1 L_nb13
L_nb13_back:
    s_waitcnt vmcnt(2)
    ds_read_b64_tr_b16 v[240:241], v19
    ds_read_b64_tr_b16 v[242:243], v19 offset:256
    s_add_u32 s47, s47, 1024
    s_and_b32 s47, s47, 4095
    s_add_u32 s48, s48, 1024
    s_and_b32 s48, s48, 4095
    s_add_u32 s55, s55, 128
    s_cmp_lg_u32 s55, s56
    s_waitcnt lgkmcnt(0)
    v_mfma_f32_16x16x32_bf16 v[144:147], v[240:243], v[244:247], v[144:147]
    s_cbranch_scc1 L_bin13
L_bin13_done:
    s_cmp_lt_u32 s88, 4
    s_cbranch_scc1 L_pr14
    s_setprio 1
L_pr14:
    v_readlane_b32 s55, v10, 14
    v_readlane_b32 s56, v12, 14
    s_cmp_eq_u32 s55, s56
    s_cbranch_scc1 L_bin14_done
L_bin14:
    s_add_u32 m0, s46, s47
    v_mad_u32_u16 v16, v98, 32, v6 op_sel:[1,0,0,0]
    v_and_b32 v18, 0xbff8, v96
    v_lshlrev_b32 v20, 4, v96
    buffer_load_dwordx4 v16, s[28:31], s57 offen  lds
    v_lshrrev_b32 v21, 7, v96
    v_cvt_f32_f16 v18, v18
    v_bfi_b32 v20, s45, v20, v21
    v_add_u32 v17, s52, v5
    v_and_or_b32 v20, v20, s44, v7
    v_mov_b32 v96, v97
    v_mov_b32 v97, v98
    ds_write_b16_d16_hi v20, v18
    ds_read_b128 v[244:247], v8
    ds_write_b16 v20, v4
    ds_read_b32 v98, v17
    v_add_u32 v19, s48, v9
    s_mov_b32 s57, s54
    s_add_u32 s52, s52, 128
    s_cmp_eq_u32 s52, s53
    s_cbranch_scc1 L_nb14
L_nb14_back:
    s_waitcnt vmcnt(2)
    ds_read_b64_tr_b16 v[240:241], v19
    ds_read_b64_tr_b16 v[242:243], v19 offset:256
    s_add_u32 s47, s47, 1024
    s_and_b32 s47, s47, 4095
    s_add_u32 s48, s48, 1024
    s_and_b32 s48, s48, 4095
    s_add_u32 s55, s55, 128
    s_cmp_lg_u32 s55, s56
    s_waitcnt lgkmcnt(0)
    v_mfma_f32_16x16x32_bf16 v[148:151], v[240:243], v[244:247], v[148:151]
    s_cbranch_scc1 L_bin14
L_bin14_done:
    s_cmp_lt_u32 s88, 4
    s_cbranch_scc1 L_pr15
    s_setprio 0
L_pr15:
    v_readlane_b32 s55, v10, 15
    v_readlane_b32 s56, v12, 15
    s_cmp_eq_u32 s55, s56
    s_cbranch_scc1 L_bin15_done
L_bin15:
    s_add_u32 m0, s46, s47
    v_mad_u32_u16 v16, v98, 32, v6 op_sel:[1,0,0,0]
    v_and_b32 v18, 0xbff8, v96
    v_lshlrev_b32 v20, 4, v96
    s_mov_b32 s58, s57
    v_lshrrev_b32 v21, 7, v96
    v_cvt_f32_f16 v18, v18
    v_bfi_b32 v20, s45, v20, v21
    v_add_u32 v17, s52, v5
    v_and_or_b32 v20, v20, s44, v7
    v_mov_b32 v96, v97
    v_mov_b32 v97, v98
    ds_write_b16_d16_hi v20, v18
    ds_read_b128 v[244:247], v8
    ds_write_b16 v20, v4
    ds_read_b32 v98, v17
    v_add_u32 v19, s48, v9
    s_mov_b32 s57, s54
    s_add_u32 s52, s52, 128
    s_cmp_eq_u32 s52, s53
    s_cbranch_scc1 L_nb15
L_nb15_back:
    s_waitcnt vmcnt(1)
    buffer_load_dwordx4 v16, s[28:31], s58 offen  lds
    ds_read_b64_tr_b16 v[240:241], v19
    ds_read_b64_tr_b16 v[242:243], v19 offset:256
    s_add_u32 s47, s47, 1024
    s_and_b32 s47, s47, 4095
    s_add_u32 s48, s48, 1024
    s_and_b32 s48, s48, 4095
    s_add_u32 s55, s55, 128
    s_cmp_lg_u32 s55, s56
    s_waitcnt lgkmcnt(0)
    v_mfma_f32_16x16x32_bf16 v[132:135], v[240:243], v[244:247], v[132:135]
    s_cbranch_scc1 L_bin15
L_bin15_done:
    s_cmp_lt_u32 s88, 4
    s_cbranch_scc1 L_pr16
    s_setprio 1
L_pr16:
    v_readlane_b32 s55, v10, 16
    v_readlane_b32 s56, v12, 16
    s_cmp_eq_u32 s55, s56
    s_cbranch_scc1 L_bin16_done
L_bin16:
    s_add_u32 m0, s46, s47
    v_mad_u32_u16 v16, v98, 32, v6 op_sel:[1,0,0,0]
    v_and_b32 v18, 0xbff8, v96
    v_lshlrev_b32 v20, 4, v96
    s_mov_b32 s58, s57
    v_lshrrev_b32 v21, 7, v96
    v_cvt_f32_f16 v18, v18
    v_bfi_b32 v20, s45, v20, v21
    v_add_u32 v17, s52, v5
    v_and_or_b32 v20, v20, s44, v7
    v_mov_b32 v96, v97
    v_mov_b32 v97, v98
    ds_write_b16_d16_hi v20, v18
    ds_read_b128 v[244:247], v8
    ds_write_b16 v20, v4
    ds_read_b32 v98, v17
    v_add_u32 v19, s48, v9
    s_mov_b32 s57, s54
    s_add_u32 s52, s52, 128
    s_cmp_eq_u32 s52, s53
    s_cbranch_scc1 L_nb16
L_nb16_back:
    s_waitcnt vmcnt(1)
    buffer_load_dwordx4 v16, s[28:31], s58 offen  lds
    ds_read_b64_tr_b16 v[240:241], v19
    ds_read_b64_tr_b16 v[242:243], v19 offset:256
    s_add_u32 s47, s47, 1024
    s_and_b32 s47, s47, 4095
    s_add_u32 s48, s48, 1024
    s_and_b32 s48, s48, 4095
    s_add_u32 s55, s55, 128
    s_cmp_lg_u32 s55, s56
    s_waitcnt lgkmcnt(0)
    v_mfma_f32_16x16x32_bf16 v[136:139], v[240:243], v[244:247], v[136:139]
    s_cbranch_scc1 L_bin16
L_bin16_done:
    s_cmp_lt_u32 s88, 4
    s_cbranch_scc1 L_pr17
    s_setprio 0
L_pr17:
    v_readlane_b32 s55, v10, 17
    v_readlane_b32 s56, v12, 17
    s_cmp_eq_u32 s55, s56
    s_cbranch_scc1 L_bin17_done
L_bin17:
    s_add_u32 m0, s46, s47
    v_mad_u32_u16 v16, v98, 32, v6 op_sel:[1,0,0,0]
    v_and_b32 v18, 0xbff8, v96
    v_lshlrev_b32 v20, 4, v96
    s_mov_b32 s58, s57
    v_lshrrev_b32 v21, 7, v96
    v_cvt_f32_f16 v18, v18
    v_bfi_b32 v20, s45, v20, v21
    v_add_u32 v17, s52, v5
    v_and_or_b32 v20, v20, s44, v7
    v_mov_b32 v96, v97
    v_mov_b32 v97, v98
    ds_write_b16_d16_hi v20, v18
    ds_read_b128 v[244:247], v8
    ds_write_b16 v20, v4
    ds_read_b32 v98, v17
    v_add_u32 v19, s48, v9
    s_mov_b32 s57, s54
    s_add_u32 s52, s52, 128
    s_cmp_eq_u32 s52, s53
    s_cbranch_scc1 L_nb17
L_nb17_back:
    s_waitcnt vmcnt(1)
    buffer_load_dwordx4 v16, s[28:31], s58 offen  lds
    ds_read_b64_tr_b16 v[240:241], v19
    ds_read_b64_tr_b16 v[242:243], v19 offset:256
    s_add_u32 s47, s47, 1024
    s_and_b32 s47, s47, 4095
    s_add_u32 s48, s48, 1024
    s_and_b32 s48, s48, 4095
    s_add_u32 s55, s55, 128
    s_cmp_lg_u32 s55, s56
    s_waitcnt lgkmcnt(0)
    v_mfma_f32_16x16x32_bf16 v[140:143], v[240:243], v[244:247], v[140:143]
    s_cbranch_scc1 L_bin17
L_bin17_done:
    s_cmp_lt_u32 s88, 4
    s_cbranch_scc1 L_pr18
    s_setprio 1
L_pr18:
    v_readlane_b32 s55, v10, 18
    v_readlane_b32 s56, v12, 18
    s_cmp_eq_u32 s55, s56
    s_cbranch_scc1 L_bin18_done
L_bin18:
    s_add_u32 m0, s46, s47
    v_mad_u32_u16 v16, v98, 32, v6 op_sel:[1,0,0,0]
    v_and_b32 v18, 0xbff8, v96
    v_lshlrev_b32 v20, 4, v96
    s_mov_b32 s58, s57
    v_lshrrev_b32 v21, 7, v96
    v_cvt_f32_f16 v18, v18
    v_bfi_b32 v20, s45, v20, v21
    v_add_u32 v17, s52, v5
    v_and_or_b32 v20, v20, s44, v7
    v_mov_b32 v96, v97
    v_mov_b32 v97, v98
    ds_write_b16_d16_hi v20, v18
    ds_read_b128 v[244:247], v8
    ds_write_b16 v20, v4
    ds_read_b32 v98, v17
    v_add_u32 v19, s48, v9
    s_mov_b32 s57, s54
    s_add_u32 s52, s52, 128
    s_cmp_eq_u32 s52, s53
    s_cbranch_scc1 L_nb18
L_nb18_back:
    s_waitcnt vmcnt(1)
    buffer_load_dwordx4 v16, s[28:31], s58 offen  lds
    ds_read_b64_tr_b16 v[240:241], v19
    ds_read_b64_tr_b16 v[242:243], v19 offset:256
    s_add_u32 s47, s47, 1024
    s_and_b32 s47, s47, 4095
    s_add_u32 s48, s48, 1024
    s_and_b32 s48, s48, 4095
    s_add_u32 s55, s55, 128
    s_cmp_lg_u32 s55, s56
    s_waitcnt lgkmcnt(0)
    v_mfma_f32_16x16x32_bf16 v[144:147], v[240:243], v[244:247], v[144:147]
    s_cbranch_scc1 L_bin18
L_bin18_done:
    s_cmp_lt_u32 s88, 4
    s_cbranch_scc1 L_pr19
    s_setprio 0
L_pr19:
    v_readlane_b32 s55, v10, 19
    v_readlane_b32 s56, v12, 19
    s_cmp_eq_u32 s55, s56
    s_cbranch_scc1 L_bin19_done
L_bin19:
    s_add_u32 m0, s46, s47
    v_mad_u32_u16 v16, v98, 32, v6 op_sel:[1,0,0,0]
    v_and_b32 v18, 0xbff8, v96
    v_lshlrev_b32 v20, 4, v96
    s_mov_b32 s58, s57
    v_lshrrev_b32 v21, 7, v96
    v_cvt_f32_f16 v18, v18
    v_bfi_b32 v20, s45, v20, v21
    v_add_u32 v17, s52, v5
    v_and_or_b32 v20, v20, s44, v7
    v_mov_b32 v96, v97
    v_mov_b32 v97, v98
    ds_write_b16_d16_hi v20, v18
    ds_read_b128 v[244:247], v8
    ds_write_b16 v20, v4
    ds_read_b32 v98, v17
    v_add_u32 v19, s48, v9
    s_mov_b32 s57, s54
    s_add_u32 s52, s52, 128
    s_cmp_eq_u32 s52, s53
    s_cbranch_scc1 L_nb19
L_nb19_back:
    s_waitcnt vmcnt(1)
    buffer_load_dwordx4 v16, s[28:31], s58 offen  lds
    ds_read_b64_tr_b16 v[240:241], v19
    ds_read_b64_tr_b16 v[242:243], v19 offset:256
    s_add_u32 s47, s47, 1024
    s_and_b32 s47, s47, 4095
    s_add_u32 s48, s48, 1024
    s_and_b32 s48, s48, 4095
    s_add_u32 s55, s55, 128
    s_cmp_lg_u32 s55, s56
    s_waitcnt lgkmcnt(0)
    v_mfma_f32_16x16x32_bf16 v[148:151], v[240:243], v[244:247], v[148:151]
    s_cbranch_scc1 L_bin19
L_bin19_done:
    s_cmp_lt_u32 s88, 4
    s_cbranch_scc1 L_pr20
    s_setprio 1
L_pr20:
    v_readlane_b32 s55, v10, 20
    v_readlane_b32 s56, v12, 20
    s_cmp_eq_u32 s55, s56
    s_cbranch_scc1 L_bin20_done
L_bin20:
    s_add_u32 m0, s46, s47
    v_mad_u32_u16 v16, v98, 32, v6 op_sel:[1,0,0,0]
    v_and_b32 v18, 0xbff8, v96
    v_lshlrev_b32 v20, 4, v96
    s_mov_b32 s58, s57
    v_lshrrev_b32 v21, 7, v96
    v_cvt_f32_f16 v18, v18
    v_bfi_b32 v20, s45, v20, v21
    v_add_u32 v17, s52, v5
    v_and_or_b32 v20, v20, s44, v7
    v_mov_b32 v96, v97
    v_mov_b32 v97, v98
    ds_write_b16_d16_hi v20, v18
    ds_read_b128 v[244:247], v8
    ds_write_b16 v20, v4
    ds_read_b32 v98, v17
    v_add_u32 v19, s48, v9
    s_mov_b32 s57, s54
    s_add_u32 s52, s52, 128
    s_cmp_eq_u32 s52, s53
    s_cbranch_scc1 L_nb20
L_nb20_back:
    s_waitcnt vmcnt(1)
    buffer_load_dwordx4 v16, s[28:31], s58 offen  lds
    ds_read_b64_tr_b16 v[240:241], v19
    ds_read_b64_tr_b16 v[242:243], v19 offset:256
    s_add_u32 s47, s47, 1024
    s_and_b32 s47, s47, 4095
    s_add_u32 s48, s48, 1024
    s_and_b32 s48, s48, 4095
    s_add_u32 s55, s55, 128
    s_cmp_lg_u32 s55, s56
    s_waitcnt lgkmcnt(0)
    v_mfma_f32_16x16x32_bf16 v[132:135], v[240:243], v[244:247], v[132:135]
    s_cbranch_scc1 L_bin20
L_bin20_done:
    s_cmp_eq_u32 s83, 0
    s_cbranch_scc1 L_epi0_done
    s_nop 5
    v_cvt_pk_bf16_f32 v20, v132, v133
    v_cvt_pk_bf16_f32 v21, v134, v135
    v_lshlrev_b32 v28, 16, v20
    v_and_b32 v29, 0xffff0000, v20
    v_lshlrev_b32 v30, 16, v21
    v_and_b32 v31, 0xffff0000, v21
    v_sub_f32 v28, v132, v28
    v_sub_f32 v29, v133, v29
    v_sub_f32 v30, v134, v30
    v_sub_f32 v31, v135, v31
    v_cvt_pk_bf16_f32 v22, v28, v29
    v_cvt_pk_bf16_f32 v23, v30, v31
    s_nop 1
    v_mfma_f32_16x16x32_bf16 v[24:27], v[224:227], v[20:23], 0
    s_nop 7
    v_mul_f32 v24, v24, v152
    v_mul_f32 v25, v25, v153
    v_mul_f32 v26, v26, v154
    v_mul_f32 v27, v27, v155
    v_cvt_pk_bf16_f32 v20, v24, v25
    v_cvt_pk_bf16_f32 v21, v26, v27
    v_lshlrev_b32 v28, 16, v20
    v_and_b32 v29, 0xffff0000, v20
    v_lshlrev_b32 v30, 16, v21
    v_and_b32 v31, 0xffff0000, v21
    v_sub_f32 v28, v24, v28
    v_sub_f32 v29, v25, v29
    v_sub_f32 v30, v26, v30
    v_sub_f32 v31, v27, v31
    v_cvt_pk_bf16_f32 v22, v28, v29
    v_cvt_pk_bf16_f32 v23, v30, v31
    s_nop 1
    v_mfma_f32_16x16x32_bf16 v[24:27], v[228:231], v[20:23], 0
    v_lshlrev_b32 v28, 16, v192
    v_and_b32 v29, 0xffff0000, v192
    v_lshlrev_b32 v30, 16, v193
    v_and_b32 v31, 0xffff0000, v193
    s_nop 3
    v_fmac_f32 v28, v24, v172
    v_fmac_f32 v29, v25, v173
    v_fmac_f32 v30, v26, v174
    v_fmac_f32 v31, v27, v175
    v_cvt_pk_bf16_f32 v192, v28, v29
    v_cvt_pk_bf16_f32 v193, v30, v31
    buffer_store_dwordx2 v[192:193], v14, s[32:35], s49 offen offset:0
L_epi0_done:
    s_cmp_lt_u32 s88, 4
    s_cbranch_scc1 L_pr21
    s_setprio 0
L_pr21:
    v_readlane_b32 s55, v10, 21
    v_readlane_b32 s56, v12, 21
    s_cmp_eq_u32 s55, s56
    s_cbranch_scc1 L_bin21_done
L_bin21:
    s_add_u32 m0, s46, s47
    v_mad_u32_u16 v16, v98, 32, v6 op_sel:[1,0,0,0]
    v_and_b32 v18, 0xbff8, v96
    v_lshlrev_b32 v20, 4, v96
    s_mov_b32 s58, s57
    v_lshrrev_b32 v21, 7, v96
    v_cvt_f32_f16 v18, v18
    v_bfi_b32 v20, s45, v20, v21
    v_add_u32 v17, s52, v5
    v_and_or_b32 v20, v20, s44, v7
    v_mov_b32 v96, v97
    v_mov_b32 v97, v98
    ds_write_b16_d16_hi v20, v18
    ds_read_b128 v[244:247], v8
    ds_write_b16 v20, v4
    ds_read_b32 v98, v17
    v_add_u32 v19, s48, v9
    s_mov_b32 s57, s54
    s_add_u32 s52, s52, 128
    s_cmp_eq_u32 s52, s53
    s_cbranch_scc1 L_nb21
L_nb21_back:
    s_waitcnt vmcnt(1)
    buffer_load_dwordx4 v16, s[28:31], s58 offen  lds
    ds_read_b64_tr_b16 v[240:241], v19
    ds_read_b64_tr_b16 v[242:243], v19 offset:256
    s_add_u32 s47, s47, 1024
    s_and_b32 s47, s47, 4095
    s_add_u32 s48, s48, 1024
    s_and_b32 s48, s48, 4095
    s_add_u32 s55, s55, 128
    s_cmp_lg_u32 s55, s56
    s_waitcnt lgkmcnt(0)
    v_mfma_f32_16x16x32_bf16 v[136:139], v[240:243], v[244:247], v[136:139]
    s_cbranch_scc1 L_bin21
L_bin21_done:
    s_cmp_eq_u32 s83, 0
    s_cbranch_scc1 L_epi1_done
    s_nop 5
    v_cvt_pk_bf16_f32 v20, v136, v137
    v_cvt_pk_bf16_f32 v21, v138, v139
    v_lshlrev_b32 v28, 16, v20
    v_and_b32 v29, 0xffff0000, v20
    v_lshlrev_b32 v30, 16, v21
    v_and_b32 v31, 0xffff0000, v21
    v_sub_f32 v28, v136, v28
    v_sub_f32 v29, v137, v29
    v_sub_f32 v30, v138, v30
    v_sub_f32 v31, v139, v31
    v_cvt_pk_bf16_f32 v22, v28, v29
    v_cvt_pk_bf16_f32 v23, v30, v31
    s_nop 1
    v_mfma_f32_16x16x32_bf16 v[24:27], v[224:227], v[20:23], 0
    s_nop 7
    v_mul_f32 v24, v24, v156
    v_mul_f32 v25, v25, v157
    v_mul_f32 v26, v26, v158
    v_mul_f32 v27, v27, v159
    v_cvt_pk_bf16_f32 v20, v24, v25
    v_cvt_pk_bf16_f32 v21, v26, v27
    v_lshlrev_b32 v28, 16, v20
    v_and_b32 v29, 0xffff0000, v20
    v_lshlrev_b32 v30, 16, v21
    v_and_b32 v31, 0xffff0000, v21
    v_sub_f32 v28, v24, v28
    v_sub_f32 v29, v25, v29
    v_sub_f32 v30, v26, v30
    v_sub_f32 v31, v27, v31
    v_cvt_pk_bf16_f32 v22, v28, v29
    v_cvt_pk_bf16_f32 v23, v30, v31
    s_nop 1
    v_mfma_f32_16x16x32_bf16 v[24:27], v[228:231], v[20:23], 0
    v_lshlrev_b32 v28, 16, v194
    v_and_b32 v29, 0xffff0000, v194
    v_lshlrev_b32 v30, 16, v195
    v_and_b32 v31, 0xffff0000, v195
    s_nop 3
    v_fmac_f32 v28, v24, v176
    v_fmac_f32 v29, v25, v177
    v_fmac_f32 v30, v26, v178
    v_fmac_f32 v31, v27, v179
    v_cvt_pk_bf16_f32 v194, v28, v29
    v_cvt_pk_bf16_f32 v195, v30, v31
    buffer_store_dwordx2 v[194:195], v14, s[32:35], s49 offen offset:512
L_epi1_done:
    s_cmp_lt_u32 s88, 4
    s_cbranch_scc1 L_pr22
    s_setprio 1
L_pr22:
    v_readlane_b32 s55, v10, 22
    v_readlane_b32 s56, v12, 22
    s_cmp_eq_u32 s55, s56
    s_cbranch_scc1 L_bin22_done
L_bin22:
    s_add_u32 m0, s46, s47
    v_mad_u32_u16 v16, v98, 32, v6 op_sel:[1,0,0,0]
    v_and_b32 v18, 0xbff8, v96
    v_lshlrev_b32 v20, 4, v96
    s_mov_b32 s58, s57
    v_lshrrev_b32 v21, 7, v96
    v_cvt_f32_f16 v18, v18
    v_bfi_b32 v20, s45, v20, v21
    v_add_u32 v17, s52, v5
    v_and_or_b32 v20, v20, s44, v7
    v_mov_b32 v96, v97
    v_mov_b32 v97, v98
    ds_write_b16_d16_hi v20, v18
    ds_read_b128 v[244:247], v8
    ds_write_b16 v20, v4
    ds_read_b32 v98, v17
    v_add_u32 v19, s48, v9
    s_mov_b32 s57, s54
    s_add_u32 s52, s52, 128
    s_cmp_eq_u32 s52, s53
    s_cbranch_scc1 L_nb22
L_nb22_back:
    s_waitcnt vmcnt(1)
    buffer_load_dwordx4 v16, s[28:31], s58 offen  lds
    ds_read_b64_tr_b16 v[240:241], v19
    ds_read_b64_tr_b16 v[242:243], v19 offset:256
    s_add_u32 s47, s47, 1024
    s_and_b32 s47, s47, 4095
    s_add_u32 s48, s48, 1024
    s_and_b32 s48, s48, 4095
    s_add_u32 s55, s55, 128
    s_cmp_lg_u32 s55, s56
    s_waitcnt lgkmcnt(0)
    v_mfma_f32_16x16x32_bf16 v[140:143], v[240:243], v[244:247], v[140:143]
    s_cbranch_scc1 L_bin22
L_bin22_done:
    s_cmp_eq_u32 s83, 0
    s_cbranch_scc1 L_epi2_done
    s_nop 5
    v_cvt_pk_bf16_f32 v20, v140, v141
    v_cvt_pk_bf16_f32 v21, v142, v143
    v_lshlrev_b32 v28, 16, v20
    v_and_b32 v29, 0xffff0000, v20
    v_lshlrev_b32 v30, 16, v21
    v_and_b32 v31, 0xffff0000, v21
    v_sub_f32 v28, v140, v28
    v_sub_f32 v29, v141, v29
    v_sub_f32 v30, v142, v30
    v_sub_f32 v31, v143, v31
    v_cvt_pk_bf16_f32 v22, v28, v29
    v_cvt_pk_bf16_f32 v23, v30, v31
    s_nop 1
    v_mfma_f32_16x16x32_bf16 v[24:27], v[224:227], v[20:23], 0
    s_nop 7
    v_mul_f32 v24, v24, v160
    v_mul_f32 v25, v25, v161
    v_mul_f32 v26, v26, v162
    v_mul_f32 v27, v27, v163
    v_cvt_pk_bf16_f32 v20, v24, v25
    v_cvt_pk_bf16_f32 v21, v26, v27
    v_lshlrev_b32 v28, 16, v20
    v_and_b32 v29, 0xffff0000, v20
    v_lshlrev_b32 v30, 16, v21
    v_and_b32 v31, 0xffff0000, v21
    v_sub_f32 v28, v24, v28
    v_sub_f32 v29, v25, v29
    v_sub_f32 v30, v26, v30
    v_sub_f32 v31, v27, v31
    v_cvt_pk_bf16_f32 v22, v28, v29
    v_cvt_pk_bf16_f32 v23, v30, v31
    s_nop 1
    v_mfma_f32_16x16x32_bf16 v[24:27], v[228:231], v[20:23], 0
    v_lshlrev_b32 v28, 16, v196
    v_and_b32 v29, 0xffff0000, v196
    v_lshlrev_b32 v30, 16, v197
    v_and_b32 v31, 0xffff0000, v197
    s_nop 3
    v_fmac_f32 v28, v24, v180
    v_fmac_f32 v29, v25, v181
    v_fmac_f32 v30, v26, v182
    v_fmac_f32 v31, v27, v183
    v_cvt_pk_bf16_f32 v196, v28, v29
    v_cvt_pk_bf16_f32 v197, v30, v31
    buffer_store_dwordx2 v[196:197], v14, s[32:35], s49 offen offset:1024
L_epi2_done:
    s_cmp_lt_u32 s88, 4
    s_cbranch_scc1 L_pr23
    s_setprio 0
L_pr23:
    v_readlane_b32 s55, v10, 23
    v_readlane_b32 s56, v12, 23
    s_cmp_eq_u32 s55, s56
    s_cbranch_scc1 L_bin23_done
L_bin23:
    s_add_u32 m0, s46, s47
    v_mad_u32_u16 v16, v98, 32, v6 op_sel:[1,0,0,0]
    v_and_b32 v18, 0xbff8, v96
    v_lshlrev_b32 v20, 4, v96
    s_mov_b32 s58, s57
    v_lshrrev_b32 v21, 7, v96
    v_cvt_f32_f16 v18, v18
    v_bfi_b32 v20, s45, v20, v21
    v_add_u32 v17, s52, v5
    v_and_or_b32 v20, v20, s44, v7
    v_mov_b32 v96, v97
    v_mov_b32 v97, v98
    ds_write_b16_d16_hi v20, v18
    ds_read_b128 v[244:247], v8
    ds_write_b16 v20, v4
    ds_read_b32 v98, v17
    v_add_u32 v19, s48, v9
    s_mov_b32 s57, s54
    s_add_u32 s52, s52, 128
    s_cmp_eq_u32 s52, s53
    s_cbranch_scc1 L_nb23
L_nb23_back:
    s_waitcnt vmcnt(1)
    buffer_load_dwordx4 v16, s[28:31], s58 offen  lds
    ds_read_b64_tr_b16 v[240:241], v19
    ds_read_b64_tr_b16 v[242:243], v19 offset:256
    s_add_u32 s47, s47, 1024
    s_and_b32 s47, s47, 4095
    s_add_u32 s48, s48, 1024
    s_and_b32 s48, s48, 4095
    s_add_u32 s55, s55, 128
    s_cmp_lg_u32 s55, s56
    s_waitcnt lgkmcnt(0)
    v_mfma_f32_16x16x32_bf16 v[144:147], v[240:243], v[244:247], v[144:147]
    s_cbranch_scc1 L_bin23
L_bin23_done:
    s_cmp_eq_u32 s83, 0
    s_cbranch_scc1 L_epi3_done
    s_nop 5
    v_cvt_pk_bf16_f32 v20, v144, v145
    v_cvt_pk_bf16_f32 v21, v146, v147
    v_lshlrev_b32 v28, 16, v20
    v_and_b32 v29, 0xffff0000, v20
    v_lshlrev_b32 v30, 16, v21
    v_and_b32 v31, 0xffff0000, v21
    v_sub_f32 v28, v144, v28
    v_sub_f32 v29, v145, v29
    v_sub_f32 v30, v146, v30
    v_sub_f32 v31, v147, v31
    v_cvt_pk_bf16_f32 v22, v28, v29
    v_cvt_pk_bf16_f32 v23, v30, v31
    s_nop 1
    v_mfma_f32_16x16x32_bf16 v[24:27], v[224:227], v[20:23], 0
    s_nop 7
    v_mul_f32 v24, v24, v164
    v_mul_f32 v25, v25, v165
    v_mul_f32 v26, v26, v166
    v_mul_f32 v27, v27, v167
    v_cvt_pk_bf16_f32 v20, v24, v25
    v_cvt_pk_bf16_f32 v21, v26, v27
    v_lshlrev_b32 v28, 16, v20
    v_and_b32 v29, 0xffff0000, v20
    v_lshlrev_b32 v30, 16, v21
    v_and_b32 v31, 0xffff0000, v21
    v_sub_f32 v28, v24, v28
    v_sub_f32 v29, v25, v29
    v_sub_f32 v30, v26, v30
    v_sub_f32 v31, v27, v31
    v_cvt_pk_bf16_f32 v22, v28, v29
    v_cvt_pk_bf16_f32 v23, v30, v31
    s_nop 1
    v_mfma_f32_16x16x32_bf16 v[24:27], v[228:231], v[20:23], 0
    v_lshlrev_b32 v28, 16, v198
    v_and_b32 v29, 0xffff0000, v198
    v_lshlrev_b32 v30, 16, v199
    v_and_b32 v31, 0xffff0000, v199
    s_nop 3
    v_fmac_f32 v28, v24, v184
    v_fmac_f32 v29, v25, v185
    v_fmac_f32 v30, v26, v186
    v_fmac_f32 v31, v27, v187
    v_cvt_pk_bf16_f32 v198, v28, v29
    v_cvt_pk_bf16_f32 v199, v30, v31
    buffer_store_dwordx2 v[198:199], v14, s[32:35], s49 offen offset:1536
L_epi3_done:
    s_cmp_lt_u32 s88, 4
    s_cbranch_scc1 L_pr24
    s_setprio 1
L_pr24:
    v_readlane_b32 s55, v10, 24
    v_readlane_b32 s56, v12, 24
    s_cmp_eq_u32 s55, s56
    s_cbranch_scc1 L_bin24_done
L_bin24:
    s_add_u32 m0, s46, s47
    v_mad_u32_u16 v16, v98, 32, v6 op_sel:[1,0,0,0]
    v_and_b32 v18, 0xbff8, v96
    v_lshlrev_b32 v20, 4, v96
    s_mov_b32 s58, s57
    v_lshrrev_b32 v21, 7, v96
    v_cvt_f32_f16 v18, v18
    v_bfi_b32 v20, s45, v20, v21
    v_add_u32 v17, s52, v5
    v_and_or_b32 v20, v20, s44, v7
    v_mov_b32 v96, v97
    v_mov_b32 v97, v98
    ds_write_b16_d16_hi v20, v18
    ds_read_b128 v[244:247], v8
    ds_write_b16 v20, v4
    ds_read_b32 v98, v17
    v_add_u32 v19, s48, v9
    s_mov_b32 s57, s54
    s_add_u32 s52, s52, 128
    s_cmp_eq_u32 s52, s53
    s_cbranch_scc1 L_nb24
L_nb24_back:
    s_waitcnt vmcnt(1)
    buffer_load_dwordx4 v16, s[28:31], s58 offen  lds
    ds_read_b64_tr_b16 v[240:241], v19
    ds_read_b64_tr_b16 v[242:243], v19 offset:256
    s_add_u32 s47, s47, 1024
    s_and_b32 s47, s47, 4095
    s_add_u32 s48, s48, 1024
    s_and_b32 s48, s48, 4095
    s_add_u32 s55, s55, 128
    s_cmp_lg_u32 s55, s56
    s_waitcnt lgkmcnt(0)
    v_mfma_f32_16x16x32_bf16 v[148:151], v[240:243], v[244:247], v[148:151]
    s_cbranch_scc1 L_bin24
L_bin24_done:
    s_cmp_eq_u32 s83, 0
    s_cbranch_scc1 L_epi4_done
    s_nop 5
    v_cvt_pk_bf16_f32 v20, v148, v149
    v_cvt_pk_bf16_f32 v21, v150, v151
    v_lshlrev_b32 v28, 16, v20
    v_and_b32 v29, 0xffff0000, v20
    v_lshlrev_b32 v30, 16, v21
    v_and_b32 v31, 0xffff0000, v21
    v_sub_f32 v28, v148, v28
    v_sub_f32 v29, v149, v29
    v_sub_f32 v30, v150, v30
    v_sub_f32 v31, v151, v31
    v_cvt_pk_bf16_f32 v22, v28, v29
    v_cvt_pk_bf16_f32 v23, v30, v31
    s_nop 1
    v_mfma_f32_16x16x32_bf16 v[24:27], v[224:227], v[20:23], 0
    s_nop 7
    v_mul_f32 v24, v24, v168
    v_mul_f32 v25, v25, v169
    v_mul_f32 v26, v26, v170
    v_mul_f32 v27, v27, v171
    v_cvt_pk_bf16_f32 v20, v24, v25
    v_cvt_pk_bf16_f32 v21, v26, v27
    v_lshlrev_b32 v28, 16, v20
    v_and_b32 v29, 0xffff0000, v20
    v_lshlrev_b32 v30, 16, v21
    v_and_b32 v31, 0xffff0000, v21
    v_sub_f32 v28, v24, v28
    v_sub_f32 v29, v25, v29
    v_sub_f32 v30, v26, v30
    v_sub_f32 v31, v27, v31
    v_cvt_pk_bf16_f32 v22, v28, v29
    v_cvt_pk_bf16_f32 v23, v30, v31
    s_nop 1
    v_mfma_f32_16x16x32_bf16 v[24:27], v[228:231], v[20:23], 0
    v_lshlrev_b32 v28, 16, v200
    v_and_b32 v29, 0xffff0000, v200
    v_lshlrev_b32 v30, 16, v201
    v_and_b32 v31, 0xffff0000, v201
    s_nop 3
    v_fmac_f32 v28, v24, v188
    v_fmac_f32 v29, v25, v189
    v_fmac_f32 v30, v26, v190
    v_fmac_f32 v31, v27, v191
    v_cvt_pk_bf16_f32 v200, v28, v29
    v_cvt_pk_bf16_f32 v201, v30, v31
    buffer_store_dwordx2 v[200:201], v15, s[32:35], s49 offen offset:2048
L_epi4_done:
    s_cmp_eq_u32 s83, 0
    s_cbranch_scc1 L_slow
L_end:
    s_endpgm
L_nb0:
    s_ff1_i32_b32 s51, s50
    s_bitset0_b32 s50, s51
    v_readlane_b32 s52, v10, s51
    v_readlane_b32 s53, v12, s51
    v_readlane_b32 s54, v13, s51
    s_branch L_nb0_back
L_nb1:
    s_ff1_i32_b32 s51, s50
    s_bitset0_b32 s50, s51
    v_readlane_b32 s52, v10, s51
    v_readlane_b32 s53, v12, s51
    v_readlane_b32 s54, v13, s51
    s_branch L_nb1_back
L_nb2:
    s_ff1_i32_b32 s51, s50
    s_bitset0_b32 s50, s51
    v_readlane_b32 s52, v10, s51
    v_readlane_b32 s53, v12, s51
    v_readlane_b32 s54, v13, s51
    s_branch L_nb2_back
L_nb3:
    s_ff1_i32_b32 s51, s50
    s_bitset0_b32 s50, s51
    v_readlane_b32 s52, v10, s51
    v_readlane_b32 s53, v12, s51
    v_readlane_b32 s54, v13, s51
    s_branch L_nb3_back
L_nb4:
    s_ff1_i32_b32 s51, s50
    s_bitset0_b32 s50, s51
    v_readlane_b32 s52, v10, s51
    v_readlane_b32 s53, v12, s51
    v_readlane_b32 s54, v13, s51
    s_branch L_nb4_back
L_nb5:
    s_ff1_i32_b32 s51, s50
    s_bitset0_b32 s50, s51
    v_readlane_b32 s52, v10, s51
    v_readlane_b32 s53, v12, s51
    v_readlane_b32 s54, v13, s51
    s_branch L_nb5_back
L_nb6:
    s_ff1_i32_b32 s51, s50
    s_bitset0_b32 s50, s51
    v_readlane_b32 s52, v10, s51
    v_readlane_b32 s53, v12, s51
    v_readlane_b32 s54, v13, s51
    s_branch L_nb6_back
L_nb7:
    s_ff1_i32_b32 s51, s50
    s_bitset0_b32 s50, s51
    v_readlane_b32 s52, v10, s51
    v_readlane_b32 s53, v12, s51
    v_readlane_b32 s54, v13, s51
    s_branch L_nb7_back
L_nb8:
    s_ff1_i32_b32 s51, s50
    s_bitset0_b32 s50, s51
    v_readlane_b32 s52, v10, s51
    v_readlane_b32 s53, v12, s51
    v_readlane_b32 s54, v13, s51
    s_branch L_nb8_back
L_nb9:
    s_ff1_i32_b32 s51, s50
    s_bitset0_b32 s50, s51
    v_readlane_b32 s52, v10, s51
    v_readlane_b32 s53, v12, s51
    v_readlane_b32 s54, v13, s51
    s_branch L_nb9_back
L_nb10:
    s_ff1_i32_b32 s51, s50
    s_bitset0_b32 s50, s51
    v_readlane_b32 s52, v10, s51
    v_readlane_b32 s53, v12, s51
    v_readlane_b32 s54, v13, s51
    s_branch L_nb10_back
L_nb11:
    s_ff1_i32_b32 s51, s50
    s_bitset0_b32 s50, s51
    v_readlane_b32 s52, v10, s51
    v_readlane_b32 s53, v12, s51
    v_readlane_b32 s54, v13, s51
    s_branch L_nb11_back
L_nb12:
    s_ff1_i32_b32 s51, s50
    s_bitset0_b32 s50, s51
    v_readlane_b32 s52, v10, s51
    v_readlane_b32 s53, v12, s51
    v_readlane_b32 s54, v13, s51
    s_branch L_nb12_back
L_nb13:
    s_ff1_i32_b32 s51, s50
    s_bitset0_b32 s50, s51
    v_readlane_b32 s52, v10, s51
    v_readlane_b32 s53, v12, s51
    v_readlane_b32 s54, v13, s51
    s_branch L_nb13_back
L_nb14:
    s_ff1_i32_b32 s51, s50
    s_bitset0_b32 s50, s51
    v_readlane_b32 s52, v10, s51
    v_readlane_b32 s53, v12, s51
    v_readlane_b32 s54, v13, s51
    s_branch L_nb14_back
L_nb15:
    s_ff1_i32_b32 s51, s50
    s_bitset0_b32 s50, s51
    v_readlane_b32 s52, v10, s51
    v_readlane_b32 s53, v12, s51
    v_readlane_b32 s54, v13, s51
    s_branch L_nb15_back
L_nb16:
    s_ff1_i32_b32 s51, s50
    s_bitset0_b32 s50, s51
    v_readlane_b32 s52, v10, s51
    v_readlane_b32 s53, v12, s51
    v_readlane_b32 s54, v13, s51
    s_branch L_nb16_back
L_nb17:
    s_ff1_i32_b32 s51, s50
    s_bitset0_b32 s50, s51
    v_readlane_b32 s52, v10, s51
    v_readlane_b32 s53, v12, s51
    v_readlane_b32 s54, v13, s51
    s_branch L_nb17_back
L_nb18:
    s_ff1_i32_b32 s51, s50
    s_bitset0_b32 s50, s51
    v_readlane_b32 s52, v10, s51
    v_readlane_b32 s53, v12, s51
    v_readlane_b32 s54, v13, s51
    s_branch L_nb18_back
L_nb19:
    s_ff1_i32_b32 s51, s50
    s_bitset0_b32 s50, s51
    v_readlane_b32 s52, v10, s51
    v_readlane_b32 s53, v12, s51
    v_readlane_b32 s54, v13, s51
    s_branch L_nb19_back
L_nb20:
    s_ff1_i32_b32 s51, s50
    s_bitset0_b32 s50, s51
    v_readlane_b32 s52, v10, s51
    v_readlane_b32 s53, v12, s51
    v_readlane_b32 s54, v13, s51
    s_branch L_nb20_back
L_nb21:
    s_ff1_i32_b32 s51, s50
    s_bitset0_b32 s50, s51
    v_readlane_b32 s52, v10, s51
    v_readlane_b32 s53, v12, s51
    v_readlane_b32 s54, v13, s51
    s_branch L_nb21_back
L_nb22:
    s_ff1_i32_b32 s51, s50
    s_bitset0_b32 s50, s51
    v_readlane_b32 s52, v10, s51
    v_readlane_b32 s53, v12, s51
    v_readlane_b32 s54, v13, s51
    s_branch L_nb22_back
L_nb23:
    s_ff1_i32_b32 s51, s50
    s_bitset0_b32 s50, s51
    v_readlane_b32 s52, v10, s51
    v_readlane_b32 s53, v12, s51
    v_readlane_b32 s54, v13, s51
    s_branch L_nb23_back
L_nb24:
    s_ff1_i32_b32 s51, s50
    s_bitset0_b32 s50, s51
    v_readlane_b32 s52, v10, s51
    v_readlane_b32 s53, v12, s51
    v_readlane_b32 s54, v13, s51
    s_branch L_nb24_back
L_code_end:
.section .rodata,"a"
.p2align 6
.amdhsa_kernel standalone__molecular_angular_gemnet__graph_kernel
  .amdhsa_next_free_vgpr 256
  .amdhsa_next_free_sgpr 102
  .amdhsa_accum_offset 256
  .amdhsa_group_segment_fixed_size 0
  .amdhsa_kernarg_size 112
  .amdhsa_user_sgpr_count 2
  .amdhsa_user_sgpr_kernarg_segment_ptr 1
  .amdhsa_system_sgpr_workgroup_id_x 1
  .amdhsa_float_denorm_mode_32 3
.end_amdhsa_kernel
```
